```python
import torch

def _softmax(x, axis=-1):
    return torch.softmax(x, dim=axis)

def _gelu(x):
    return torch.nn.functional.gelu(x, approximate='tanh')

def _silu(x):
    return torch.nn.functional.silu(x)

def _sigmoid(x):
    return torch.sigmoid(x)

def _layernorm(x, axis=-1, eps=1e-05):
    m = x.mean(dim=axis, keepdim=True)
    v = x.var(dim=axis, keepdim=True, unbiased=False)
    return (x - m) / torch.sqrt(v + eps)

def _scatter_add(tgt, idx, src, axis=0):
    return tgt.clone().index_add_(axis, idx, src)

def _segment_sum(src, seg, n):
    out = torch.zeros((n,) + src.shape[1:], dtype=src.dtype)
    return out.index_add_(0, seg, src)

def _pad(x, pw):
    flat = tuple((v for pair in reversed(pw) for v in pair))
    return torch.nn.functional.pad(x, flat)
kernel_name = 'standalone__molecular_angular_painn__graph'

def setup_inputs():

    _w = lambda a: (lambda t: t.to(torch.bfloat16) if t.is_floating_point() else t)(torch.as_tensor(a))
    N, deg, D = (10000, 16, 256)
    n_rbf = max(0, 4)
    E = N * deg
    cutoff = 5.0
    freqs = (torch.arange(1, n_rbf + 1) * torch.pi / cutoff).to(float)
    return {'sv': _w((lambda *s: torch.randn(*s, dtype=torch.bfloat16) * 0.4)(N, 4, D) * 0.3), 'pos': _w((lambda *s: torch.randn(*s, dtype=torch.bfloat16) * 3.2)(N, 3) * 1.2), 'src': _w((lambda lo, hi, *s: torch.randint(lo, hi, s))(0, N, E).to(torch.int64)), 'dst': _w((lambda lo, hi, *s: torch.randint(lo, hi, s))(0, N, E).to(torch.int64)), 'freqs': _w(freqs), 'w_phi1': _w((lambda *s: torch.randn(*s, dtype=torch.bfloat16) * 3.2)(D, D) / D ** 0.5), 'w_phi2': _w((lambda *s: torch.randn(*s, dtype=torch.bfloat16) * 3.2)(D, 3 * D) / D ** 0.5), 'w_rbf': _w((lambda *s: torch.randn(*s, dtype=torch.bfloat16) * 3.2)(n_rbf, 3 * D) / n_rbf ** 0.5)}

def reference(sv, pos, src, dst, freqs, w_phi1, w_phi2, w_rbf):
    N, _, D = sv.shape
    E = src.shape[0]
    PI, cutoff = (3.141592653589793, 5.0)
    s, v = (sv[:, 0, :].clone(), sv[:, 1:, :].clone())
    r_vec = pos[src] - pos[dst]
    d = torch.sqrt((r_vec * r_vec).sum(-1) + 1e-08)
    r_hat = r_vec / d[:, None]
    rbf = torch.sin(d[:, None] * freqs[None, :]) / d[:, None]
    fcut = 0.5 * (torch.cos(PI * d / cutoff) + 1.0)
    fcut = torch.where(d < cutoff, fcut, 0.0 * d)
    Wf = rbf @ w_rbf * fcut[:, None]
    phi = (_silu(s @ w_phi1) @ w_phi2)[src]
    m = phi * Wf
    m_s, m_vv, m_vr = (m[:, :D].clone(), m[:, D:2 * D].clone(), m[:, 2 * D:].clone())
    ds = _segment_sum(m_s, dst, N)
    dv_e = m_vv[:, None, :] * v[src] + m_vr[:, None, :] * r_hat[:, :, None]
    dv = _segment_sum(dv_e.reshape(E, 3 * D), dst, N).reshape(N, 3, D)
    return sv + torch.concatenate([ds[:, None, :], dv], axis=1)
```

```asm
; @launch kernel=painn_k1_kernel grid=(256,1,1) block=(768,1,1) lds=147520
; @launch kernel=painn_k2_kernel grid=(256,1,1) block=(1024,1,1) lds=119808
.amdgcn_target "amdgcn-amd-amdhsa--gfx950"
.text
.globl painn_k1_kernel
.p2align 8
.type painn_k1_kernel,@function
painn_k1_kernel:
    s_cmp_ge_u32 s2, 256
    s_cbranch_scc1 L_k1_exit
    s_load_dwordx16 s[16:31], s[0:1], 0
    s_load_dwordx4 s[32:35], s[0:1], 64
    s_load_dwordx2 s[36:37], s[0:1], 80
    s_getpc_b64 s[90:91]
L_pc_k1:
    s_sub_u32 s90, s90, (L_pc_k1 - painn_k1_kernel)
    s_subb_u32 s91, s91, 0
    v_lshrrev_b32 v160, 6, v0
    s_lshr_b32 s92, s2, 3
    s_mul_i32 s92, s92, 12
    v_add_u32 v160, s92, v160
    v_lshlrev_b32 v160, 10, v160
    v_and_b32 v161, 63, v0
    v_lshl_add_u32 v160, v161, 4, v160
    v_cmp_gt_u32 vcc, ((L_code_end - painn_k1_kernel) & 0xfffffff0), v160
    s_and_saveexec_b64 s[92:93], vcc
    s_cbranch_execz L_pf_k1
    global_load_dwordx4 v[164:167], v160, s[90:91]
L_pf_k1:
    s_mov_b64 exec, s[92:93]
    s_cmp_lt_u32 s2, 40
    s_cbranch_scc1 L_k1_edge
    s_cmp_lt_u32 s2, 250
    s_cbranch_scc1 L_k1_gemm
    v_and_b32 v2, 63, v0
    v_lshrrev_b32 v1, 6, v0
    s_waitcnt lgkmcnt(0)
    v_readfirstlane_b32 s79, v1
    s_mov_b32 s80, s16
    s_mov_b32 s81, s17
    s_mov_b32 s82, 20480000
    s_mov_b32 s83, 0x00020000
    s_lshr_b32 s72, s2, 3
    s_mul_i32 s72, s72, 313
    v_lshrrev_b32 v8, 4, v2
    v_add_u32 v8, s72, v8
    v_lshlrev_b32 v8, 11, v8
    v_bfe_u32 v9, v2, 3, 1
    v_lshl_add_u32 v8, v9, 9, v8
    v_and_b32 v9, 7, v2
    v_lshl_add_u32 v8, v9, 4, v8
    s_and_b32 s72, s2, 1
    s_lshl_b32 s72, s72, 10
    s_bfe_u32 s73, s2, 0x20001
    s_lshl_b32 s73, s73, 7
    s_add_u32 s72, s72, s73
    v_add_u32 v8, s72, v8
    s_add_u32 s72, s79, 0
    s_lshl_b32 s72, s72, 13
    buffer_load_dwordx4 v[16:19], v8, s[80:83], s72 offen
    s_add_u32 s72, s79, 12
    s_lshl_b32 s72, s72, 13
    buffer_load_dwordx4 v[20:23], v8, s[80:83], s72 offen
    s_add_u32 s72, s79, 24
    s_lshl_b32 s72, s72, 13
    buffer_load_dwordx4 v[24:27], v8, s[80:83], s72 offen
    s_add_u32 s72, s79, 36
    s_lshl_b32 s72, s72, 13
    buffer_load_dwordx4 v[28:31], v8, s[80:83], s72 offen
    s_add_u32 s72, s79, 48
    s_lshl_b32 s72, s72, 13
    buffer_load_dwordx4 v[32:35], v8, s[80:83], s72 offen
    s_add_u32 s72, s79, 60
    s_lshl_b32 s72, s72, 13
    buffer_load_dwordx4 v[36:39], v8, s[80:83], s72 offen
    s_add_u32 s72, s79, 72
    s_cmp_ge_u32 s72, 79
    s_cbranch_scc1 L_l2pf_16_12
    s_lshl_b32 s72, s72, 13
    buffer_load_dwordx4 v[40:43], v8, s[80:83], s72 offen
L_l2pf_16_12:
    s_endpgm
L_k1_gemm:
    s_sub_u32 s60, s2, 40
    s_lshr_b32 s61, s60, 3
    s_lshl_b32 s61, s61, 2
    s_and_b32 s62, s60, 3
    s_add_u32 s61, s61, s62
    s_lshr_b32 s62, s60, 2
    s_and_b32 s62, s62, 1
    s_cmp_ge_u32 s60, 208
    s_cselect_b32 s61, 104, s61
    s_and_b32 s60, s60, 1
    s_sub_u32 s63, s2, 40
    s_cmp_ge_u32 s63, 208
    s_cselect_b32 s60, s60, s62
    s_mul_i32 s57, s61, 96
    v_lshrrev_b32 v1, 6, v0
    v_and_b32 v2, 63, v0
    s_lshl_b32 s63, s60, 8
    s_waitcnt lgkmcnt(0)
    v_readfirstlane_b32 s56, v1
    s_mov_b32 s40, s16
    s_mov_b32 s41, s17
    s_mov_b32 s42, 20480000
    s_mov_b32 s43, 0x00020000
    s_mov_b32 s52, s36
    s_mov_b32 s53, s37
    s_mov_b32 s54, 15482880
    s_mov_b32 s55, 0x00020000
    v_mov_b32 v3, 0
    v_mov_b32 v4, 147456
    v_mov_b32 v5, 0
    v_mov_b32 v6, 0
    v_mov_b32 v7, 0
    v_mov_b32 v8, 0
    v_mov_b32 v9, 0
    ds_write_b128 v4, v[6:9]
    ds_write_b128 v4, v[6:9] offset:16
    s_cmp_ge_u32 s56, 8
    s_cbranch_scc1 L_copy_role
    s_mov_b32 s44, s26
    s_mov_b32 s45, s27
    s_mov_b32 s46, 131072
    s_mov_b32 s47, 0x00020000
    s_mov_b32 s48, s28
    s_mov_b32 s49, s29
    s_mov_b32 s50, 393216
    s_mov_b32 s51, 0x00020000
    s_and_b32 s58, s56, 3
    s_lshr_b32 s59, s56, 2
    v_lshrrev_b32 v92, 5, v2
    v_and_b32 v93, 31, v2
    s_mul_i32 s62, s56, 6
    s_add_u32 s64, s62, 0
    s_lshl_b32 s65, s64, 1
    v_add_u32 v94, s65, v92
    v_and_b32 v95, 15, v94
    v_xor_b32 v95, v95, v93
    v_add_u32 v94, s57, v94
    v_lshlrev_b32 v94, 11, v94
    v_lshl_add_u32 v94, v95, 4, v94
    s_lshl_b32 s65, s64, 10
    s_mov_b32 m0, s65
    s_nop 0
    buffer_load_dwordx4 v94, s[40:43], 0 offen  lds
    s_add_u32 s64, s62, 1
    s_lshl_b32 s65, s64, 1
    v_add_u32 v94, s65, v92
    v_and_b32 v95, 15, v94
    v_xor_b32 v95, v95, v93
    v_add_u32 v94, s57, v94
    v_lshlrev_b32 v94, 11, v94
    v_lshl_add_u32 v94, v95, 4, v94
    s_lshl_b32 s65, s64, 10
    s_mov_b32 m0, s65
    s_nop 0
    buffer_load_dwordx4 v94, s[40:43], 0 offen  lds
    s_add_u32 s64, s62, 2
    s_lshl_b32 s65, s64, 1
    v_add_u32 v94, s65, v92
    v_and_b32 v95, 15, v94
    v_xor_b32 v95, v95, v93
    v_add_u32 v94, s57, v94
    v_lshlrev_b32 v94, 11, v94
    v_lshl_add_u32 v94, v95, 4, v94
    s_lshl_b32 s65, s64, 10
    s_mov_b32 m0, s65
    s_nop 0
    buffer_load_dwordx4 v94, s[40:43], 0 offen  lds
    s_add_u32 s64, s62, 3
    s_lshl_b32 s65, s64, 1
    v_add_u32 v94, s65, v92
    v_and_b32 v95, 15, v94
    v_xor_b32 v95, v95, v93
    v_add_u32 v94, s57, v94
    v_lshlrev_b32 v94, 11, v94
    v_lshl_add_u32 v94, v95, 4, v94
    s_lshl_b32 s65, s64, 10
    s_mov_b32 m0, s65
    s_nop 0
    buffer_load_dwordx4 v94, s[40:43], 0 offen  lds
    s_add_u32 s64, s62, 4
    s_lshl_b32 s65, s64, 1
    v_add_u32 v94, s65, v92
    v_and_b32 v95, 15, v94
    v_xor_b32 v95, v95, v93
    v_add_u32 v94, s57, v94
    v_lshlrev_b32 v94, 11, v94
    v_lshl_add_u32 v94, v95, 4, v94
    s_lshl_b32 s65, s64, 10
    s_mov_b32 m0, s65
    s_nop 0
    buffer_load_dwordx4 v94, s[40:43], 0 offen  lds
    s_add_u32 s64, s62, 5
    s_lshl_b32 s65, s64, 1
    v_add_u32 v94, s65, v92
    v_and_b32 v95, 15, v94
    v_xor_b32 v95, v95, v93
    v_add_u32 v94, s57, v94
    v_lshlrev_b32 v94, 11, v94
    v_lshl_add_u32 v94, v95, 4, v94
    s_lshl_b32 s65, s64, 10
    s_mov_b32 m0, s65
    s_nop 0
    buffer_load_dwordx4 v94, s[40:43], 0 offen  lds
    s_lshl_b32 s62, s56, 2
    v_add_u32 v94, s62, v92
    v_and_b32 v95, 3, v94
    v_bfe_u32 v97, v94, 3, 1
    v_lshl_or_b32 v95, v97, 2, v95
    v_lshlrev_b32 v95, 1, v95
    v_xor_b32 v95, v95, v93
    v_lshlrev_b32 v96, 4, v95
    v_lshl_add_u32 v3, v94, 9, v96
    v_mul_u32_u24 v5, 1536, v94
    v_lshrrev_b32 v96, 4, v95
    v_lshl_add_u32 v5, v96, 9, v5
    v_and_b32 v96, 15, v95
    v_lshl_add_u32 v5, v96, 4, v5
    v_add_u32 v5, s63, v5
    v_add_u32 v94, s62, v92
    v_add_u32 v94, 2, v94
    v_and_b32 v95, 3, v94
    v_bfe_u32 v97, v94, 3, 1
    v_lshl_or_b32 v95, v97, 2, v95
    v_lshlrev_b32 v95, 1, v95
    v_xor_b32 v95, v95, v93
    v_lshlrev_b32 v96, 4, v95
    v_lshl_add_u32 v4, v94, 9, v96
    v_subrev_u32 v4, 1024, v4
    v_mul_u32_u24 v6, 1536, v94
    v_lshrrev_b32 v96, 4, v95
    v_lshl_add_u32 v6, v96, 9, v6
    v_and_b32 v96, 15, v95
    v_lshl_add_u32 v6, v96, 4, v6
    v_add_u32 v6, s63, v6
    v_subrev_u32 v6, 1024, v6
    s_lshl_b32 s65, s56, 11
    s_lshl_b32 s66, s56, 10
    s_add_u32 s67, s65, 49152
    s_mov_b32 m0, s67
    s_mov_b32 s68, 0
    buffer_load_dwordx4 v3, s[44:47], s68 offen offset:0  lds
    buffer_load_dwordx4 v4, s[44:47], s68 offen offset:1024  lds
    s_add_u32 s67, s65, 65536
    s_mov_b32 m0, s67
    s_mov_b32 s68, 16384
    buffer_load_dwordx4 v3, s[44:47], s68 offen offset:0  lds
    buffer_load_dwordx4 v4, s[44:47], s68 offen offset:1024  lds
    s_add_u32 s67, s65, 81920
    s_mov_b32 m0, s67
    s_mov_b32 s68, 32768
    buffer_load_dwordx4 v3, s[44:47], s68 offen offset:0  lds
    buffer_load_dwordx4 v4, s[44:47], s68 offen offset:1024  lds
    s_add_u32 s67, s65, 98304
    s_mov_b32 m0, s67
    s_mov_b32 s68, 49152
    buffer_load_dwordx4 v3, s[44:47], s68 offen offset:0  lds
    buffer_load_dwordx4 v4, s[44:47], s68 offen offset:1024  lds
    s_add_u32 s67, s65, 114688
    s_mov_b32 m0, s67
    s_mov_b32 s68, 65536
    buffer_load_dwordx4 v3, s[44:47], s68 offen offset:0  lds
    buffer_load_dwordx4 v4, s[44:47], s68 offen offset:1024  lds
    s_add_u32 s67, s65, 131072
    s_mov_b32 m0, s67
    s_mov_b32 s68, 81920
    buffer_load_dwordx4 v3, s[44:47], s68 offen offset:0  lds
    buffer_load_dwordx4 v4, s[44:47], s68 offen offset:1024  lds
    s_waitcnt lgkmcnt(0)
    s_barrier
    v_lshrrev_b32 v92, 4, v2
    v_bfe_u32 v93, v2, 2, 2
    v_and_b32 v94, 3, v2
    v_lshl_add_u32 v95, v92, 3, v93
    v_and_b32 v96, 1, v92
    v_lshl_or_b32 v96, v96, 2, v93
    s_and_b32 s72, s58, 1
    s_lshl_b32 s72, s72, 2
    v_xor_b32 v97, s72, v96
    v_lshlrev_b32 v97, 5, v97
    v_lshl_add_u32 v97, v95, 9, v97
    v_lshl_add_u32 v97, v94, 3, v97
    s_lshr_b32 s72, s58, 1
    s_lshl_b32 s72, s72, 8
    s_add_u32 s72, s72, 49152
    v_add_u32 v97, s72, v97
    v_xor_b32 v7, 0, v97
    v_xor_b32 v8, 32, v97
    v_xor_b32 v9, 64, v97
    v_xor_b32 v10, 96, v97
    s_lshl_b32 s72, s58, 1
    v_xor_b32 v97, s72, v96
    v_lshlrev_b32 v97, 5, v97
    v_lshl_add_u32 v97, v94, 3, v97
    v_add_u32 v97, 49152, v97
    v_lshl_add_u32 v11, v95, 9, v97
    v_xor_b32 v12, 32, v11
    v_and_b32 v93, 15, v2
    v_and_b32 v94, 3, v2
    v_xor_b32 v94, v94, v92
    v_lshlrev_b32 v94, 4, v94
    v_lshl_add_u32 v94, v93, 9, v94
    v_bfe_u32 v95, v2, 2, 2
    v_lshl_add_u32 v94, v95, 6, v94
    s_mul_i32 s72, s59, 24576
    v_add_u32 v94, s72, v94
    v_xor_b32 v13, 0, v94
    v_xor_b32 v14, 64, v94
    v_xor_b32 v15, 128, v94
    v_xor_b32 v16, 192, v94
    v_lshrrev_b32 v95, 1, v92
    s_lshl_b32 s73, s58, 3
    v_add_u32 v95, s73, v95
    v_xor_b32 v95, v95, v93
    v_lshlrev_b32 v95, 4, v95
    v_lshl_add_u32 v95, v93, 9, v95
    v_and_b32 v96, 1, v92
    v_lshl_add_u32 v17, v96, 3, v95
    v_add_u32 v17, s72, v17
    v_lshrrev_b32 v95, 1, v92
    s_lshl_b32 s73, s58, 2
    v_add_u32 v95, s73, v95
    v_xor_b32 v95, v95, v93
    v_lshlrev_b32 v95, 4, v95
    v_lshl_add_u32 v95, v93, 8, v95
    v_lshl_add_u32 v18, v96, 3, v95
    s_mul_i32 s73, s59, 12288
    s_add_u32 s73, s73, 114688
    v_add_u32 v18, s73, v18
    s_mul_i32 s69, s59, 48
    s_add_u32 s69, s69, s57
    s_lshl_b32 s71, s60, 1
    s_lshr_b32 s70, s58, 1
    s_add_u32 s71, s71, s70
    s_mul_i32 s71, s71, 3870720
    s_and_b32 s70, s58, 1
    s_lshl_b32 s70, s70, 7
    s_add_u32 s71, s71, s70
    v_and_b32 v95, 7, v2
    v_add_u32 v95, s69, v95
    v_mul_u32_u24 v19, 384, v95
    v_bfe_u32 v95, v2, 3, 1
    v_lshl_add_u32 v95, v95, 2, v92
    v_lshl_add_u32 v19, v95, 4, v19
    v_add_u32 v19, s71, v19
    s_waitcnt vmcnt(0)
    s_mov_b64 exec, 1
    v_mov_b32 v20, 147456
    v_mov_b32 v21, 1
    ds_add_u32 v20, v21
    s_mov_b64 exec, -1
    v_mov_b32 v20, 147456
L_g_sp1:
    ds_read_b32 v21, v20
    s_waitcnt lgkmcnt(0)
    v_readfirstlane_b32 s74, v21
    s_cmp_ge_u32 s74, 8
    s_cbranch_scc0 L_g_sp1
    ds_read_b64_tr_b16 v[36:37], v7 offset:0
    ds_read_b64_tr_b16 v[38:39], v7 offset:2048
    ds_read_b64_tr_b16 v[40:41], v8 offset:0
    ds_read_b64_tr_b16 v[42:43], v8 offset:2048
    ds_read_b64_tr_b16 v[44:45], v9 offset:0
    ds_read_b64_tr_b16 v[46:47], v9 offset:2048
    ds_read_b64_tr_b16 v[48:49], v10 offset:0
    ds_read_b64_tr_b16 v[50:51], v10 offset:2048
    ds_read_b128 v[68:71], v13 offset:0
    ds_read_b128 v[72:75], v13 offset:8192
    ds_read_b128 v[76:79], v13 offset:16384
    s_waitcnt lgkmcnt(0)
    v_mfma_f32_16x16x32_bf16 v[92:95], v[36:39], v[68:71], 0
    v_mfma_f32_16x16x32_bf16 v[96:99], v[36:39], v[72:75], 0
    v_mfma_f32_16x16x32_bf16 v[100:103], v[36:39], v[76:79], 0
    ds_read_b64_tr_b16 v[52:53], v7 offset:16384
    ds_read_b64_tr_b16 v[54:55], v7 offset:18432
    v_mfma_f32_16x16x32_bf16 v[104:107], v[40:43], v[68:71], 0
    ds_read_b64_tr_b16 v[56:57], v8 offset:16384
    ds_read_b64_tr_b16 v[58:59], v8 offset:18432
    v_mfma_f32_16x16x32_bf16 v[108:111], v[40:43], v[72:75], 0
    ds_read_b64_tr_b16 v[60:61], v9 offset:16384
    ds_read_b64_tr_b16 v[62:63], v9 offset:18432
    v_mfma_f32_16x16x32_bf16 v[112:115], v[40:43], v[76:79], 0
    ds_read_b64_tr_b16 v[64:65], v10 offset:16384
    ds_read_b64_tr_b16 v[66:67], v10 offset:18432
    v_mfma_f32_16x16x32_bf16 v[116:119], v[44:47], v[68:71], 0
    ds_read_b128 v[80:83], v14 offset:0
    ds_read_b128 v[84:87], v14 offset:8192
    v_mfma_f32_16x16x32_bf16 v[120:123], v[44:47], v[72:75], 0
    ds_read_b128 v[88:91], v14 offset:16384
    v_mfma_f32_16x16x32_bf16 v[124:127], v[44:47], v[76:79], 0
    v_mfma_f32_16x16x32_bf16 v[128:131], v[48:51], v[68:71], 0
    v_mfma_f32_16x16x32_bf16 v[132:135], v[48:51], v[72:75], 0
    v_mfma_f32_16x16x32_bf16 v[136:139], v[48:51], v[76:79], 0
    s_waitcnt lgkmcnt(0)
    v_mfma_f32_16x16x32_bf16 v[92:95], v[52:55], v[80:83], v[92:95]
    v_mfma_f32_16x16x32_bf16 v[96:99], v[52:55], v[84:87], v[96:99]
    s_mov_b64 exec, 1
    v_mov_b32 v20, 147460
    v_mov_b32 v21, 1
    ds_add_u32 v20, v21
    s_mov_b64 exec, -1
    v_mfma_f32_16x16x32_bf16 v[100:103], v[52:55], v[88:91], v[100:103]
    ds_read_b64_tr_b16 v[36:37], v7 offset:32768
    ds_read_b64_tr_b16 v[38:39], v7 offset:34816
    v_mfma_f32_16x16x32_bf16 v[104:107], v[56:59], v[80:83], v[104:107]
    ds_read_b64_tr_b16 v[40:41], v8 offset:32768
    ds_read_b64_tr_b16 v[42:43], v8 offset:34816
    v_mfma_f32_16x16x32_bf16 v[108:111], v[56:59], v[84:87], v[108:111]
    ds_read_b64_tr_b16 v[44:45], v9 offset:32768
    ds_read_b64_tr_b16 v[46:47], v9 offset:34816
    v_mfma_f32_16x16x32_bf16 v[112:115], v[56:59], v[88:91], v[112:115]
    ds_read_b64_tr_b16 v[48:49], v10 offset:32768
    ds_read_b64_tr_b16 v[50:51], v10 offset:34816
    v_mfma_f32_16x16x32_bf16 v[116:119], v[60:63], v[80:83], v[116:119]
    ds_read_b128 v[68:71], v15 offset:0
    ds_read_b128 v[72:75], v15 offset:8192
    v_mfma_f32_16x16x32_bf16 v[120:123], v[60:63], v[84:87], v[120:123]
    ds_read_b128 v[76:79], v15 offset:16384
    v_mfma_f32_16x16x32_bf16 v[124:127], v[60:63], v[88:91], v[124:127]
    v_mfma_f32_16x16x32_bf16 v[128:131], v[64:67], v[80:83], v[128:131]
    v_mfma_f32_16x16x32_bf16 v[132:135], v[64:67], v[84:87], v[132:135]
    v_mfma_f32_16x16x32_bf16 v[136:139], v[64:67], v[88:91], v[136:139]
    s_waitcnt lgkmcnt(0)
    v_mfma_f32_16x16x32_bf16 v[92:95], v[36:39], v[68:71], v[92:95]
    v_mfma_f32_16x16x32_bf16 v[96:99], v[36:39], v[72:75], v[96:99]
    v_mov_b32 v20, 147460
L_g_sp2:
    ds_read_b32 v21, v20
    s_waitcnt lgkmcnt(0)
    v_readfirstlane_b32 s74, v21
    s_cmp_ge_u32 s74, 8
    s_cbranch_scc0 L_g_sp2
    s_add_u32 s67, s65, 49152
    s_mov_b32 m0, s67
    s_mov_b32 s68, 98304
    buffer_load_dwordx4 v3, s[44:47], s68 offen offset:0  lds
    buffer_load_dwordx4 v4, s[44:47], s68 offen offset:1024  lds
    s_add_u32 s67, s65, 65536
    s_mov_b32 m0, s67
    s_mov_b32 s68, 114688
    buffer_load_dwordx4 v3, s[44:47], s68 offen offset:0  lds
    buffer_load_dwordx4 v4, s[44:47], s68 offen offset:1024  lds
    s_mov_b64 exec, 1
    v_mov_b32 v20, 147472
    v_mov_b32 v21, 1
    ds_add_u32 v20, v21
    s_mov_b64 exec, -1
    v_mfma_f32_16x16x32_bf16 v[100:103], v[36:39], v[76:79], v[100:103]
    ds_read_b64_tr_b16 v[52:53], v7 offset:49152
    ds_read_b64_tr_b16 v[54:55], v7 offset:51200
    v_mfma_f32_16x16x32_bf16 v[104:107], v[40:43], v[68:71], v[104:107]
    ds_read_b64_tr_b16 v[56:57], v8 offset:49152
    ds_read_b64_tr_b16 v[58:59], v8 offset:51200
    v_mfma_f32_16x16x32_bf16 v[108:111], v[40:43], v[72:75], v[108:111]
    ds_read_b64_tr_b16 v[60:61], v9 offset:49152
    ds_read_b64_tr_b16 v[62:63], v9 offset:51200
    v_mfma_f32_16x16x32_bf16 v[112:115], v[40:43], v[76:79], v[112:115]
    ds_read_b64_tr_b16 v[64:65], v10 offset:49152
    ds_read_b64_tr_b16 v[66:67], v10 offset:51200
    v_mfma_f32_16x16x32_bf16 v[116:119], v[44:47], v[68:71], v[116:119]
    ds_read_b128 v[80:83], v16 offset:0
    ds_read_b128 v[84:87], v16 offset:8192
    v_mfma_f32_16x16x32_bf16 v[120:123], v[44:47], v[72:75], v[120:123]
    ds_read_b128 v[88:91], v16 offset:16384
    v_mfma_f32_16x16x32_bf16 v[124:127], v[44:47], v[76:79], v[124:127]
    v_mfma_f32_16x16x32_bf16 v[128:131], v[48:51], v[68:71], v[128:131]
    v_mfma_f32_16x16x32_bf16 v[132:135], v[48:51], v[72:75], v[132:135]
    v_mfma_f32_16x16x32_bf16 v[136:139], v[48:51], v[76:79], v[136:139]
    s_waitcnt lgkmcnt(0)
    v_mfma_f32_16x16x32_bf16 v[92:95], v[52:55], v[80:83], v[92:95]
    v_mfma_f32_16x16x32_bf16 v[96:99], v[52:55], v[84:87], v[96:99]
    v_mfma_f32_16x16x32_bf16 v[100:103], v[52:55], v[88:91], v[100:103]
    v_add_u32 v7, 0x10000, v7
    v_add_u32 v8, 0x10000, v8
    v_mfma_f32_16x16x32_bf16 v[104:107], v[56:59], v[80:83], v[104:107]
    v_add_u32 v9, 0x10000, v9
    v_add_u32 v10, 0x10000, v10
    v_mfma_f32_16x16x32_bf16 v[108:111], v[56:59], v[84:87], v[108:111]
    ds_read_b64_tr_b16 v[36:37], v7 offset:0
    ds_read_b64_tr_b16 v[38:39], v7 offset:2048
    v_mfma_f32_16x16x32_bf16 v[112:115], v[56:59], v[88:91], v[112:115]
    ds_read_b64_tr_b16 v[40:41], v8 offset:0
    ds_read_b64_tr_b16 v[42:43], v8 offset:2048
    v_mfma_f32_16x16x32_bf16 v[116:119], v[60:63], v[80:83], v[116:119]
    ds_read_b64_tr_b16 v[44:45], v9 offset:0
    ds_read_b64_tr_b16 v[46:47], v9 offset:2048
    v_mfma_f32_16x16x32_bf16 v[120:123], v[60:63], v[84:87], v[120:123]
    ds_read_b64_tr_b16 v[48:49], v10 offset:0
    ds_read_b64_tr_b16 v[50:51], v10 offset:2048
    v_mfma_f32_16x16x32_bf16 v[124:127], v[60:63], v[88:91], v[124:127]
    ds_read_b128 v[68:71], v13 offset:256
    ds_read_b128 v[72:75], v13 offset:8448
    v_mfma_f32_16x16x32_bf16 v[128:131], v[64:67], v[80:83], v[128:131]
    ds_read_b128 v[76:79], v13 offset:16640
    v_mfma_f32_16x16x32_bf16 v[132:135], v[64:67], v[84:87], v[132:135]
    v_mfma_f32_16x16x32_bf16 v[136:139], v[64:67], v[88:91], v[136:139]
    s_waitcnt lgkmcnt(0)
    v_mfma_f32_16x16x32_bf16 v[92:95], v[36:39], v[68:71], v[92:95]
    v_mfma_f32_16x16x32_bf16 v[96:99], v[36:39], v[72:75], v[96:99]
    s_waitcnt vmcnt(0)
    s_mov_b64 exec, 1
    v_mov_b32 v20, 147464
    v_mov_b32 v21, 1
    ds_add_u32 v20, v21
    s_mov_b64 exec, -1
    v_mfma_f32_16x16x32_bf16 v[100:103], v[36:39], v[76:79], v[100:103]
    ds_read_b64_tr_b16 v[52:53], v7 offset:16384
    ds_read_b64_tr_b16 v[54:55], v7 offset:18432
    v_mfma_f32_16x16x32_bf16 v[104:107], v[40:43], v[68:71], v[104:107]
    ds_read_b64_tr_b16 v[56:57], v8 offset:16384
    ds_read_b64_tr_b16 v[58:59], v8 offset:18432
    v_mfma_f32_16x16x32_bf16 v[108:111], v[40:43], v[72:75], v[108:111]
    ds_read_b64_tr_b16 v[60:61], v9 offset:16384
    ds_read_b64_tr_b16 v[62:63], v9 offset:18432
    v_mfma_f32_16x16x32_bf16 v[112:115], v[40:43], v[76:79], v[112:115]
    ds_read_b64_tr_b16 v[64:65], v10 offset:16384
    ds_read_b64_tr_b16 v[66:67], v10 offset:18432
    v_mfma_f32_16x16x32_bf16 v[116:119], v[44:47], v[68:71], v[116:119]
    ds_read_b128 v[80:83], v14 offset:256
    ds_read_b128 v[84:87], v14 offset:8448
    v_mfma_f32_16x16x32_bf16 v[120:123], v[44:47], v[72:75], v[120:123]
    ds_read_b128 v[88:91], v14 offset:16640
    v_mfma_f32_16x16x32_bf16 v[124:127], v[44:47], v[76:79], v[124:127]
    v_mfma_f32_16x16x32_bf16 v[128:131], v[48:51], v[68:71], v[128:131]
    v_mfma_f32_16x16x32_bf16 v[132:135], v[48:51], v[72:75], v[132:135]
    v_mfma_f32_16x16x32_bf16 v[136:139], v[48:51], v[76:79], v[136:139]
    s_waitcnt lgkmcnt(0)
    v_mfma_f32_16x16x32_bf16 v[92:95], v[52:55], v[80:83], v[92:95]
    v_mfma_f32_16x16x32_bf16 v[96:99], v[52:55], v[84:87], v[96:99]
    v_mov_b32 v20, 147464
L_g_sp3:
    ds_read_b32 v21, v20
    s_waitcnt lgkmcnt(0)
    v_readfirstlane_b32 s74, v21
    s_cmp_ge_u32 s74, 8
    s_cbranch_scc0 L_g_sp3
    v_mfma_f32_16x16x32_bf16 v[100:103], v[52:55], v[88:91], v[100:103]
    v_subrev_u32 v7, 0x10000, v7
    v_subrev_u32 v8, 0x10000, v8
    v_mfma_f32_16x16x32_bf16 v[104:107], v[56:59], v[80:83], v[104:107]
    v_subrev_u32 v9, 0x10000, v9
    v_subrev_u32 v10, 0x10000, v10
    v_mfma_f32_16x16x32_bf16 v[108:111], v[56:59], v[84:87], v[108:111]
    ds_read_b64_tr_b16 v[36:37], v7 offset:0
    ds_read_b64_tr_b16 v[38:39], v7 offset:2048
    v_mfma_f32_16x16x32_bf16 v[112:115], v[56:59], v[88:91], v[112:115]
    ds_read_b64_tr_b16 v[40:41], v8 offset:0
    ds_read_b64_tr_b16 v[42:43], v8 offset:2048
    v_mfma_f32_16x16x32_bf16 v[116:119], v[60:63], v[80:83], v[116:119]
    ds_read_b64_tr_b16 v[44:45], v9 offset:0
    ds_read_b64_tr_b16 v[46:47], v9 offset:2048
    v_mfma_f32_16x16x32_bf16 v[120:123], v[60:63], v[84:87], v[120:123]
    ds_read_b64_tr_b16 v[48:49], v10 offset:0
    ds_read_b64_tr_b16 v[50:51], v10 offset:2048
    v_mfma_f32_16x16x32_bf16 v[124:127], v[60:63], v[88:91], v[124:127]
    ds_read_b128 v[68:71], v15 offset:256
    ds_read_b128 v[72:75], v15 offset:8448
    v_mfma_f32_16x16x32_bf16 v[128:131], v[64:67], v[80:83], v[128:131]
    ds_read_b128 v[76:79], v15 offset:16640
    v_mfma_f32_16x16x32_bf16 v[132:135], v[64:67], v[84:87], v[132:135]
    v_mfma_f32_16x16x32_bf16 v[136:139], v[64:67], v[88:91], v[136:139]
    s_waitcnt lgkmcnt(0)
    v_mfma_f32_16x16x32_bf16 v[92:95], v[36:39], v[68:71], v[92:95]
    v_mfma_f32_16x16x32_bf16 v[96:99], v[36:39], v[72:75], v[96:99]
    v_mfma_f32_16x16x32_bf16 v[100:103], v[36:39], v[76:79], v[100:103]
    ds_read_b64_tr_b16 v[52:53], v7 offset:16384
    ds_read_b64_tr_b16 v[54:55], v7 offset:18432
    v_mfma_f32_16x16x32_bf16 v[104:107], v[40:43], v[68:71], v[104:107]
    ds_read_b64_tr_b16 v[56:57], v8 offset:16384
    ds_read_b64_tr_b16 v[58:59], v8 offset:18432
    v_mfma_f32_16x16x32_bf16 v[108:111], v[40:43], v[72:75], v[108:111]
    ds_read_b64_tr_b16 v[60:61], v9 offset:16384
    ds_read_b64_tr_b16 v[62:63], v9 offset:18432
    v_mfma_f32_16x16x32_bf16 v[112:115], v[40:43], v[76:79], v[112:115]
    ds_read_b64_tr_b16 v[64:65], v10 offset:16384
    ds_read_b64_tr_b16 v[66:67], v10 offset:18432
    v_mfma_f32_16x16x32_bf16 v[116:119], v[44:47], v[68:71], v[116:119]
    ds_read_b128 v[80:83], v16 offset:256
    ds_read_b128 v[84:87], v16 offset:8448
    v_mfma_f32_16x16x32_bf16 v[120:123], v[44:47], v[72:75], v[120:123]
    ds_read_b128 v[88:91], v16 offset:16640
    v_mfma_f32_16x16x32_bf16 v[124:127], v[44:47], v[76:79], v[124:127]
    v_mfma_f32_16x16x32_bf16 v[128:131], v[48:51], v[68:71], v[128:131]
    v_mfma_f32_16x16x32_bf16 v[132:135], v[48:51], v[72:75], v[132:135]
    v_mfma_f32_16x16x32_bf16 v[136:139], v[48:51], v[76:79], v[136:139]
    s_waitcnt lgkmcnt(0)
    v_mfma_f32_16x16x32_bf16 v[92:95], v[52:55], v[80:83], v[92:95]
    v_mfma_f32_16x16x32_bf16 v[96:99], v[52:55], v[84:87], v[96:99]
    s_mov_b64 exec, 1
    v_mov_b32 v20, 147468
    v_mov_b32 v21, 1
    ds_add_u32 v20, v21
    s_mov_b64 exec, -1
    v_mfma_f32_16x16x32_bf16 v[100:103], v[52:55], v[88:91], v[100:103]
    v_mfma_f32_16x16x32_bf16 v[104:107], v[56:59], v[80:83], v[104:107]
    v_mfma_f32_16x16x32_bf16 v[108:111], v[56:59], v[84:87], v[108:111]
    v_mfma_f32_16x16x32_bf16 v[112:115], v[56:59], v[88:91], v[112:115]
    v_mfma_f32_16x16x32_bf16 v[116:119], v[60:63], v[80:83], v[116:119]
    v_mfma_f32_16x16x32_bf16 v[120:123], v[60:63], v[84:87], v[120:123]
    v_mfma_f32_16x16x32_bf16 v[124:127], v[60:63], v[88:91], v[124:127]
    v_mfma_f32_16x16x32_bf16 v[128:131], v[64:67], v[80:83], v[128:131]
    v_mfma_f32_16x16x32_bf16 v[132:135], v[64:67], v[84:87], v[132:135]
    v_mfma_f32_16x16x32_bf16 v[136:139], v[64:67], v[88:91], v[136:139]
    v_mov_b32 v20, 147468
L_g_sp4:
    ds_read_b32 v21, v20
    s_waitcnt lgkmcnt(0)
    v_readfirstlane_b32 s74, v21
    s_cmp_ge_u32 s74, 8
    s_cbranch_scc0 L_g_sp4
    v_lshrrev_b32 v20, 4, v2
    v_bfe_u32 v21, v2, 2, 2
    v_lshl_add_u32 v20, v20, 3, v21
    v_lshlrev_b32 v20, 8, v20
    v_sub_u32 v7, v11, v20
    v_xor_b32 v8, 32, v7
    v_mul_f32 v24, 0xbfb8aa3b, v92
    v_mul_f32 v25, 0xbfb8aa3b, v93
    v_mul_f32 v26, 0xbfb8aa3b, v94
    v_mul_f32 v27, 0xbfb8aa3b, v95
    v_mul_f32 v28, 0xbfb8aa3b, v96
    v_mul_f32 v29, 0xbfb8aa3b, v97
    v_mul_f32 v30, 0xbfb8aa3b, v98
    v_mul_f32 v31, 0xbfb8aa3b, v99
    v_exp_f32 v24, v24
    v_exp_f32 v25, v25
    v_exp_f32 v26, v26
    v_exp_f32 v27, v27
    v_exp_f32 v28, v28
    v_exp_f32 v29, v29
    v_exp_f32 v30, v30
    v_exp_f32 v31, v31
    v_add_f32 v24, 1.0, v24
    v_add_f32 v25, 1.0, v25
    v_add_f32 v26, 1.0, v26
    v_add_f32 v27, 1.0, v27
    v_add_f32 v28, 1.0, v28
    v_add_f32 v29, 1.0, v29
    v_add_f32 v30, 1.0, v30
    v_add_f32 v31, 1.0, v31
    v_rcp_f32 v24, v24
    v_rcp_f32 v25, v25
    v_rcp_f32 v26, v26
    v_rcp_f32 v27, v27
    v_rcp_f32 v28, v28
    v_rcp_f32 v29, v29
    v_rcp_f32 v30, v30
    v_rcp_f32 v31, v31
    v_mul_f32 v24, v24, v92
    v_mul_f32 v25, v25, v93
    v_mul_f32 v26, v26, v94
    v_mul_f32 v27, v27, v95
    v_mul_f32 v28, v28, v96
    v_mul_f32 v29, v29, v97
    v_mul_f32 v30, v30, v98
    v_mul_f32 v31, v31, v99
    v_cvt_pk_bf16_f32 v32, v24, v25
    v_cvt_pk_bf16_f32 v33, v26, v27
    v_xor_b32 v20, 0, v17
    ds_write_b64 v20, v[32:33] offset:0
    v_cvt_pk_bf16_f32 v34, v28, v29
    v_cvt_pk_bf16_f32 v35, v30, v31
    v_xor_b32 v21, 0, v17
    ds_write_b64 v21, v[34:35] offset:8192
    v_mul_f32 v24, 0xbfb8aa3b, v100
    v_mul_f32 v25, 0xbfb8aa3b, v101
    v_mul_f32 v26, 0xbfb8aa3b, v102
    v_mul_f32 v27, 0xbfb8aa3b, v103
    v_mul_f32 v28, 0xbfb8aa3b, v104
    v_mul_f32 v29, 0xbfb8aa3b, v105
    v_mul_f32 v30, 0xbfb8aa3b, v106
    v_mul_f32 v31, 0xbfb8aa3b, v107
    v_exp_f32 v24, v24
    v_exp_f32 v25, v25
    v_exp_f32 v26, v26
    v_exp_f32 v27, v27
    v_exp_f32 v28, v28
    v_exp_f32 v29, v29
    v_exp_f32 v30, v30
    v_exp_f32 v31, v31
    v_add_f32 v24, 1.0, v24
    v_add_f32 v25, 1.0, v25
    v_add_f32 v26, 1.0, v26
    v_add_f32 v27, 1.0, v27
    v_add_f32 v28, 1.0, v28
    v_add_f32 v29, 1.0, v29
    v_add_f32 v30, 1.0, v30
    v_add_f32 v31, 1.0, v31
    v_rcp_f32 v24, v24
    v_rcp_f32 v25, v25
    v_rcp_f32 v26, v26
    v_rcp_f32 v27, v27
    v_rcp_f32 v28, v28
    v_rcp_f32 v29, v29
    v_rcp_f32 v30, v30
    v_rcp_f32 v31, v31
    v_mul_f32 v24, v24, v100
    v_mul_f32 v25, v25, v101
    v_mul_f32 v26, v26, v102
    v_mul_f32 v27, v27, v103
    v_mul_f32 v28, v28, v104
    v_mul_f32 v29, v29, v105
    v_mul_f32 v30, v30, v106
    v_mul_f32 v31, v31, v107
    v_cvt_pk_bf16_f32 v32, v24, v25
    v_cvt_pk_bf16_f32 v33, v26, v27
    v_xor_b32 v20, 0, v17
    ds_write_b64 v20, v[32:33] offset:16384
    v_cvt_pk_bf16_f32 v34, v28, v29
    v_cvt_pk_bf16_f32 v35, v30, v31
    v_xor_b32 v21, 32, v17
    ds_write_b64 v21, v[34:35] offset:0
    v_mul_f32 v24, 0xbfb8aa3b, v108
    v_mul_f32 v25, 0xbfb8aa3b, v109
    v_mul_f32 v26, 0xbfb8aa3b, v110
    v_mul_f32 v27, 0xbfb8aa3b, v111
    v_mul_f32 v28, 0xbfb8aa3b, v112
    v_mul_f32 v29, 0xbfb8aa3b, v113
    v_mul_f32 v30, 0xbfb8aa3b, v114
    v_mul_f32 v31, 0xbfb8aa3b, v115
    v_exp_f32 v24, v24
    v_exp_f32 v25, v25
    v_exp_f32 v26, v26
    v_exp_f32 v27, v27
    v_exp_f32 v28, v28
    v_exp_f32 v29, v29
    v_exp_f32 v30, v30
    v_exp_f32 v31, v31
    v_add_f32 v24, 1.0, v24
    v_add_f32 v25, 1.0, v25
    v_add_f32 v26, 1.0, v26
    v_add_f32 v27, 1.0, v27
    v_add_f32 v28, 1.0, v28
    v_add_f32 v29, 1.0, v29
    v_add_f32 v30, 1.0, v30
    v_add_f32 v31, 1.0, v31
    v_rcp_f32 v24, v24
    v_rcp_f32 v25, v25
    v_rcp_f32 v26, v26
    v_rcp_f32 v27, v27
    v_rcp_f32 v28, v28
    v_rcp_f32 v29, v29
    v_rcp_f32 v30, v30
    v_rcp_f32 v31, v31
    v_mul_f32 v24, v24, v108
    v_mul_f32 v25, v25, v109
    v_mul_f32 v26, v26, v110
    v_mul_f32 v27, v27, v111
    v_mul_f32 v28, v28, v112
    v_mul_f32 v29, v29, v113
    v_mul_f32 v30, v30, v114
    v_mul_f32 v31, v31, v115
    v_cvt_pk_bf16_f32 v32, v24, v25
    v_cvt_pk_bf16_f32 v33, v26, v27
    v_xor_b32 v20, 32, v17
    ds_write_b64 v20, v[32:33] offset:8192
    v_cvt_pk_bf16_f32 v34, v28, v29
    v_cvt_pk_bf16_f32 v35, v30, v31
    v_xor_b32 v21, 32, v17
    ds_write_b64 v21, v[34:35] offset:16384
    v_mul_f32 v24, 0xbfb8aa3b, v116
    v_mul_f32 v25, 0xbfb8aa3b, v117
    v_mul_f32 v26, 0xbfb8aa3b, v118
    v_mul_f32 v27, 0xbfb8aa3b, v119
    v_mul_f32 v28, 0xbfb8aa3b, v120
    v_mul_f32 v29, 0xbfb8aa3b, v121
    v_mul_f32 v30, 0xbfb8aa3b, v122
    v_mul_f32 v31, 0xbfb8aa3b, v123
    v_exp_f32 v24, v24
    v_exp_f32 v25, v25
    v_exp_f32 v26, v26
    v_exp_f32 v27, v27
    v_exp_f32 v28, v28
    v_exp_f32 v29, v29
    v_exp_f32 v30, v30
    v_exp_f32 v31, v31
    v_add_f32 v24, 1.0, v24
    v_add_f32 v25, 1.0, v25
    v_add_f32 v26, 1.0, v26
    v_add_f32 v27, 1.0, v27
    v_add_f32 v28, 1.0, v28
    v_add_f32 v29, 1.0, v29
    v_add_f32 v30, 1.0, v30
    v_add_f32 v31, 1.0, v31
    v_rcp_f32 v24, v24
    v_rcp_f32 v25, v25
    v_rcp_f32 v26, v26
    v_rcp_f32 v27, v27
    v_rcp_f32 v28, v28
    v_rcp_f32 v29, v29
    v_rcp_f32 v30, v30
    v_rcp_f32 v31, v31
    v_mul_f32 v24, v24, v116
    v_mul_f32 v25, v25, v117
    v_mul_f32 v26, v26, v118
    v_mul_f32 v27, v27, v119
    v_mul_f32 v28, v28, v120
    v_mul_f32 v29, v29, v121
    v_mul_f32 v30, v30, v122
    v_mul_f32 v31, v31, v123
    v_cvt_pk_bf16_f32 v32, v24, v25
    v_cvt_pk_bf16_f32 v33, v26, v27
    v_xor_b32 v20, 64, v17
    ds_write_b64 v20, v[32:33] offset:0
    v_cvt_pk_bf16_f32 v34, v28, v29
    v_cvt_pk_bf16_f32 v35, v30, v31
    v_xor_b32 v21, 64, v17
    ds_write_b64 v21, v[34:35] offset:8192
    v_mul_f32 v24, 0xbfb8aa3b, v124
    v_mul_f32 v25, 0xbfb8aa3b, v125
    v_mul_f32 v26, 0xbfb8aa3b, v126
    v_mul_f32 v27, 0xbfb8aa3b, v127
    v_mul_f32 v28, 0xbfb8aa3b, v128
    v_mul_f32 v29, 0xbfb8aa3b, v129
    v_mul_f32 v30, 0xbfb8aa3b, v130
    v_mul_f32 v31, 0xbfb8aa3b, v131
    v_exp_f32 v24, v24
    v_exp_f32 v25, v25
    v_exp_f32 v26, v26
    v_exp_f32 v27, v27
    v_exp_f32 v28, v28
    v_exp_f32 v29, v29
    v_exp_f32 v30, v30
    v_exp_f32 v31, v31
    v_add_f32 v24, 1.0, v24
    v_add_f32 v25, 1.0, v25
    v_add_f32 v26, 1.0, v26
    v_add_f32 v27, 1.0, v27
    v_add_f32 v28, 1.0, v28
    v_add_f32 v29, 1.0, v29
    v_add_f32 v30, 1.0, v30
    v_add_f32 v31, 1.0, v31
    v_rcp_f32 v24, v24
    v_rcp_f32 v25, v25
    v_rcp_f32 v26, v26
    v_rcp_f32 v27, v27
    v_rcp_f32 v28, v28
    v_rcp_f32 v29, v29
    v_rcp_f32 v30, v30
    v_rcp_f32 v31, v31
    v_mul_f32 v24, v24, v124
    v_mul_f32 v25, v25, v125
    v_mul_f32 v26, v26, v126
    v_mul_f32 v27, v27, v127
    v_mul_f32 v28, v28, v128
    v_mul_f32 v29, v29, v129
    v_mul_f32 v30, v30, v130
    v_mul_f32 v31, v31, v131
    v_cvt_pk_bf16_f32 v32, v24, v25
    v_cvt_pk_bf16_f32 v33, v26, v27
    v_xor_b32 v20, 64, v17
    ds_write_b64 v20, v[32:33] offset:16384
    v_cvt_pk_bf16_f32 v34, v28, v29
    v_cvt_pk_bf16_f32 v35, v30, v31
    v_xor_b32 v21, 96, v17
    ds_write_b64 v21, v[34:35] offset:0
    v_mul_f32 v24, 0xbfb8aa3b, v132
    v_mul_f32 v25, 0xbfb8aa3b, v133
    v_mul_f32 v26, 0xbfb8aa3b, v134
    v_mul_f32 v27, 0xbfb8aa3b, v135
    v_mul_f32 v28, 0xbfb8aa3b, v136
    v_mul_f32 v29, 0xbfb8aa3b, v137
    v_mul_f32 v30, 0xbfb8aa3b, v138
    v_mul_f32 v31, 0xbfb8aa3b, v139
    v_exp_f32 v24, v24
    v_exp_f32 v25, v25
    v_exp_f32 v26, v26
    v_exp_f32 v27, v27
    v_exp_f32 v28, v28
    v_exp_f32 v29, v29
    v_exp_f32 v30, v30
    v_exp_f32 v31, v31
    v_add_f32 v24, 1.0, v24
    v_add_f32 v25, 1.0, v25
    v_add_f32 v26, 1.0, v26
    v_add_f32 v27, 1.0, v27
    v_add_f32 v28, 1.0, v28
    v_add_f32 v29, 1.0, v29
    v_add_f32 v30, 1.0, v30
    v_add_f32 v31, 1.0, v31
    v_rcp_f32 v24, v24
    v_rcp_f32 v25, v25
    v_rcp_f32 v26, v26
    v_rcp_f32 v27, v27
    v_rcp_f32 v28, v28
    v_rcp_f32 v29, v29
    v_rcp_f32 v30, v30
    v_rcp_f32 v31, v31
    v_mul_f32 v24, v24, v132
    v_mul_f32 v25, v25, v133
    v_mul_f32 v26, v26, v134
    v_mul_f32 v27, v27, v135
    v_mul_f32 v28, v28, v136
    v_mul_f32 v29, v29, v137
    v_mul_f32 v30, v30, v138
    v_mul_f32 v31, v31, v139
    v_cvt_pk_bf16_f32 v32, v24, v25
    v_cvt_pk_bf16_f32 v33, v26, v27
    v_xor_b32 v20, 96, v17
    ds_write_b64 v20, v[32:33] offset:8192
    v_cvt_pk_bf16_f32 v34, v28, v29
    v_cvt_pk_bf16_f32 v35, v30, v31
    v_xor_b32 v21, 96, v17
    ds_write_b64 v21, v[34:35] offset:16384
    s_waitcnt lgkmcnt(0)
    s_barrier
    ds_read_b64_tr_b16 v[36:37], v7 offset:0
    ds_read_b64_tr_b16 v[38:39], v7 offset:1024
    ds_read_b64_tr_b16 v[40:41], v8 offset:0
    ds_read_b64_tr_b16 v[42:43], v8 offset:1024
    ds_read_b128 v[68:71], v13 offset:0
    ds_read_b128 v[72:75], v13 offset:8192
    ds_read_b128 v[76:79], v13 offset:16384
    s_waitcnt lgkmcnt(0)
    v_mfma_f32_16x16x32_bf16 v[140:143], v[36:39], v[68:71], 0
    v_mfma_f32_16x16x32_bf16 v[144:147], v[36:39], v[72:75], 0
    ds_read_b64_tr_b16 v[52:53], v7 offset:8192
    ds_read_b64_tr_b16 v[54:55], v7 offset:9216
    v_mfma_f32_16x16x32_bf16 v[148:151], v[36:39], v[76:79], 0
    ds_read_b64_tr_b16 v[56:57], v8 offset:8192
    ds_read_b64_tr_b16 v[58:59], v8 offset:9216
    v_mfma_f32_16x16x32_bf16 v[152:155], v[40:43], v[68:71], 0
    ds_read_b128 v[80:83], v14 offset:0
    ds_read_b128 v[84:87], v14 offset:8192
    v_mfma_f32_16x16x32_bf16 v[156:159], v[40:43], v[72:75], 0
    ds_read_b128 v[88:91], v14 offset:16384
    v_mfma_f32_16x16x32_bf16 v[160:163], v[40:43], v[76:79], 0
    s_waitcnt lgkmcnt(0)
    v_mfma_f32_16x16x32_bf16 v[140:143], v[52:55], v[80:83], v[140:143]
    s_barrier
    v_mfma_f32_16x16x32_bf16 v[144:147], v[52:55], v[84:87], v[144:147]
    ds_read_b64_tr_b16 v[36:37], v7 offset:16384
    ds_read_b64_tr_b16 v[38:39], v7 offset:17408
    v_mfma_f32_16x16x32_bf16 v[148:151], v[52:55], v[88:91], v[148:151]
    ds_read_b64_tr_b16 v[40:41], v8 offset:16384
    ds_read_b64_tr_b16 v[42:43], v8 offset:17408
    v_mfma_f32_16x16x32_bf16 v[152:155], v[56:59], v[80:83], v[152:155]
    ds_read_b128 v[68:71], v15 offset:0
    ds_read_b128 v[72:75], v15 offset:8192
    v_mfma_f32_16x16x32_bf16 v[156:159], v[56:59], v[84:87], v[156:159]
    ds_read_b128 v[76:79], v15 offset:16384
    v_mfma_f32_16x16x32_bf16 v[160:163], v[56:59], v[88:91], v[160:163]
    s_waitcnt lgkmcnt(0)
    v_mfma_f32_16x16x32_bf16 v[140:143], v[36:39], v[68:71], v[140:143]
    v_mfma_f32_16x16x32_bf16 v[144:147], v[36:39], v[72:75], v[144:147]
    ds_read_b64_tr_b16 v[52:53], v7 offset:24576
    ds_read_b64_tr_b16 v[54:55], v7 offset:25600
    v_mfma_f32_16x16x32_bf16 v[148:151], v[36:39], v[76:79], v[148:151]
    ds_read_b64_tr_b16 v[56:57], v8 offset:24576
    ds_read_b64_tr_b16 v[58:59], v8 offset:25600
    v_mfma_f32_16x16x32_bf16 v[152:155], v[40:43], v[68:71], v[152:155]
    ds_read_b128 v[80:83], v16 offset:0
    ds_read_b128 v[84:87], v16 offset:8192
    v_mfma_f32_16x16x32_bf16 v[156:159], v[40:43], v[72:75], v[156:159]
    ds_read_b128 v[88:91], v16 offset:16384
    v_mfma_f32_16x16x32_bf16 v[160:163], v[40:43], v[76:79], v[160:163]
    s_waitcnt lgkmcnt(0)
    v_mfma_f32_16x16x32_bf16 v[140:143], v[52:55], v[80:83], v[140:143]
    s_barrier
    v_mfma_f32_16x16x32_bf16 v[144:147], v[52:55], v[84:87], v[144:147]
    ds_read_b64_tr_b16 v[36:37], v7 offset:32768
    ds_read_b64_tr_b16 v[38:39], v7 offset:33792
    v_mfma_f32_16x16x32_bf16 v[148:151], v[52:55], v[88:91], v[148:151]
    ds_read_b64_tr_b16 v[40:41], v8 offset:32768
    ds_read_b64_tr_b16 v[42:43], v8 offset:33792
    v_mfma_f32_16x16x32_bf16 v[152:155], v[56:59], v[80:83], v[152:155]
    ds_read_b128 v[68:71], v13 offset:256
    ds_read_b128 v[72:75], v13 offset:8448
    v_mfma_f32_16x16x32_bf16 v[156:159], v[56:59], v[84:87], v[156:159]
    ds_read_b128 v[76:79], v13 offset:16640
    v_mfma_f32_16x16x32_bf16 v[160:163], v[56:59], v[88:91], v[160:163]
    s_waitcnt lgkmcnt(0)
    v_mfma_f32_16x16x32_bf16 v[140:143], v[36:39], v[68:71], v[140:143]
    v_mfma_f32_16x16x32_bf16 v[144:147], v[36:39], v[72:75], v[144:147]
    ds_read_b64_tr_b16 v[52:53], v7 offset:40960
    ds_read_b64_tr_b16 v[54:55], v7 offset:41984
    v_mfma_f32_16x16x32_bf16 v[148:151], v[36:39], v[76:79], v[148:151]
    ds_read_b64_tr_b16 v[56:57], v8 offset:40960
    ds_read_b64_tr_b16 v[58:59], v8 offset:41984
    v_mfma_f32_16x16x32_bf16 v[152:155], v[40:43], v[68:71], v[152:155]
    ds_read_b128 v[80:83], v14 offset:256
    ds_read_b128 v[84:87], v14 offset:8448
    v_mfma_f32_16x16x32_bf16 v[156:159], v[40:43], v[72:75], v[156:159]
    ds_read_b128 v[88:91], v14 offset:16640
    v_mfma_f32_16x16x32_bf16 v[160:163], v[40:43], v[76:79], v[160:163]
    s_waitcnt lgkmcnt(0)
    v_mfma_f32_16x16x32_bf16 v[140:143], v[52:55], v[80:83], v[140:143]
    s_barrier
    v_mfma_f32_16x16x32_bf16 v[144:147], v[52:55], v[84:87], v[144:147]
    ds_read_b64_tr_b16 v[36:37], v7 offset:49152
    ds_read_b64_tr_b16 v[38:39], v7 offset:50176
    v_mfma_f32_16x16x32_bf16 v[148:151], v[52:55], v[88:91], v[148:151]
    ds_read_b64_tr_b16 v[40:41], v8 offset:49152
    ds_read_b64_tr_b16 v[42:43], v8 offset:50176
    v_mfma_f32_16x16x32_bf16 v[152:155], v[56:59], v[80:83], v[152:155]
    ds_read_b128 v[68:71], v15 offset:256
    ds_read_b128 v[72:75], v15 offset:8448
    v_mfma_f32_16x16x32_bf16 v[156:159], v[56:59], v[84:87], v[156:159]
    ds_read_b128 v[76:79], v15 offset:16640
    v_mfma_f32_16x16x32_bf16 v[160:163], v[56:59], v[88:91], v[160:163]
    s_waitcnt lgkmcnt(0)
    v_mfma_f32_16x16x32_bf16 v[140:143], v[36:39], v[68:71], v[140:143]
    v_mfma_f32_16x16x32_bf16 v[144:147], v[36:39], v[72:75], v[144:147]
    ds_read_b64_tr_b16 v[52:53], v7 offset:57344
    ds_read_b64_tr_b16 v[54:55], v7 offset:58368
    v_mfma_f32_16x16x32_bf16 v[148:151], v[36:39], v[76:79], v[148:151]
    ds_read_b64_tr_b16 v[56:57], v8 offset:57344
    ds_read_b64_tr_b16 v[58:59], v8 offset:58368
    v_mfma_f32_16x16x32_bf16 v[152:155], v[40:43], v[68:71], v[152:155]
    ds_read_b128 v[80:83], v16 offset:256
    ds_read_b128 v[84:87], v16 offset:8448
    v_mfma_f32_16x16x32_bf16 v[156:159], v[40:43], v[72:75], v[156:159]
    ds_read_b128 v[88:91], v16 offset:16640
    v_mfma_f32_16x16x32_bf16 v[160:163], v[40:43], v[76:79], v[160:163]
    s_waitcnt lgkmcnt(0)
    v_mfma_f32_16x16x32_bf16 v[140:143], v[52:55], v[80:83], v[140:143]
    s_barrier
    v_mfma_f32_16x16x32_bf16 v[144:147], v[52:55], v[84:87], v[144:147]
    ds_read_b64_tr_b16 v[36:37], v11 offset:0
    ds_read_b64_tr_b16 v[38:39], v11 offset:2048
    ds_read_b64_tr_b16 v[40:41], v12 offset:0
    v_mfma_f32_16x16x32_bf16 v[148:151], v[52:55], v[88:91], v[148:151]
    ds_read_b64_tr_b16 v[42:43], v12 offset:2048
    ds_read_b64_tr_b16 v[44:45], v11 offset:256
    ds_read_b64_tr_b16 v[46:47], v11 offset:2304
    v_mfma_f32_16x16x32_bf16 v[152:155], v[56:59], v[80:83], v[152:155]
    ds_read_b64_tr_b16 v[48:49], v12 offset:256
    ds_read_b64_tr_b16 v[50:51], v12 offset:2304
    ds_read_b128 v[68:71], v13 offset:0
    v_mfma_f32_16x16x32_bf16 v[156:159], v[56:59], v[84:87], v[156:159]
    ds_read_b128 v[72:75], v13 offset:8192
    ds_read_b128 v[76:79], v13 offset:16384
    v_mfma_f32_16x16x32_bf16 v[160:163], v[56:59], v[88:91], v[160:163]
    s_waitcnt lgkmcnt(0)
    v_mfma_f32_16x16x32_bf16 v[92:95], v[36:39], v[68:71], 0
    v_mfma_f32_16x16x32_bf16 v[96:99], v[36:39], v[72:75], 0
    s_barrier
    v_mfma_f32_16x16x32_bf16 v[100:103], v[36:39], v[76:79], 0
    ds_read_b64_tr_b16 v[52:53], v11 offset:16384
    ds_read_b64_tr_b16 v[54:55], v11 offset:18432
    v_mfma_f32_16x16x32_bf16 v[104:107], v[40:43], v[68:71], 0
    ds_read_b64_tr_b16 v[56:57], v12 offset:16384
    ds_read_b64_tr_b16 v[58:59], v12 offset:18432
    v_mfma_f32_16x16x32_bf16 v[108:111], v[40:43], v[72:75], 0
    ds_read_b64_tr_b16 v[60:61], v11 offset:16640
    ds_read_b64_tr_b16 v[62:63], v11 offset:18688
    v_mfma_f32_16x16x32_bf16 v[112:115], v[40:43], v[76:79], 0
    ds_read_b64_tr_b16 v[64:65], v12 offset:16640
    ds_read_b64_tr_b16 v[66:67], v12 offset:18688
    v_mfma_f32_16x16x32_bf16 v[116:119], v[44:47], v[68:71], 0
    ds_read_b128 v[80:83], v14 offset:0
    ds_read_b128 v[84:87], v14 offset:8192
    v_mfma_f32_16x16x32_bf16 v[120:123], v[44:47], v[72:75], 0
    ds_read_b128 v[88:91], v14 offset:16384
    v_cvt_pk_bf16_f32 v24, v140, v141
    v_mfma_f32_16x16x32_bf16 v[124:127], v[44:47], v[76:79], 0
    v_cvt_pk_bf16_f32 v25, v142, v143
    v_cvt_pk_bf16_f32 v26, v152, v153
    v_mfma_f32_16x16x32_bf16 v[128:131], v[48:51], v[68:71], 0
    v_cvt_pk_bf16_f32 v27, v154, v155
    v_xor_b32 v20, 32, v18
    v_mfma_f32_16x16x32_bf16 v[132:135], v[48:51], v[72:75], 0
    ds_write_b64 v18, v[24:25] offset:0
    ds_write_b64 v20, v[26:27] offset:0
    v_mfma_f32_16x16x32_bf16 v[136:139], v[48:51], v[76:79], 0
    s_waitcnt lgkmcnt(0)
    v_mfma_f32_16x16x32_bf16 v[92:95], v[52:55], v[80:83], v[92:95]
    v_mfma_f32_16x16x32_bf16 v[96:99], v[52:55], v[84:87], v[96:99]
    s_barrier
    v_mfma_f32_16x16x32_bf16 v[100:103], v[52:55], v[88:91], v[100:103]
    ds_read_b64_tr_b16 v[36:37], v11 offset:32768
    ds_read_b64_tr_b16 v[38:39], v11 offset:34816
    v_mfma_f32_16x16x32_bf16 v[104:107], v[56:59], v[80:83], v[104:107]
    ds_read_b64_tr_b16 v[40:41], v12 offset:32768
    ds_read_b64_tr_b16 v[42:43], v12 offset:34816
    v_mfma_f32_16x16x32_bf16 v[108:111], v[56:59], v[84:87], v[108:111]
    ds_read_b64_tr_b16 v[44:45], v11 offset:33024
    ds_read_b64_tr_b16 v[46:47], v11 offset:35072
    v_mfma_f32_16x16x32_bf16 v[112:115], v[56:59], v[88:91], v[112:115]
    ds_read_b64_tr_b16 v[48:49], v12 offset:33024
    ds_read_b64_tr_b16 v[50:51], v12 offset:35072
    v_mfma_f32_16x16x32_bf16 v[116:119], v[60:63], v[80:83], v[116:119]
    ds_read_b128 v[68:71], v15 offset:0
    ds_read_b128 v[72:75], v15 offset:8192
    v_mfma_f32_16x16x32_bf16 v[120:123], v[60:63], v[84:87], v[120:123]
    ds_read_b128 v[76:79], v15 offset:16384
    v_cvt_pk_bf16_f32 v24, v144, v145
    v_mfma_f32_16x16x32_bf16 v[124:127], v[60:63], v[88:91], v[124:127]
    v_cvt_pk_bf16_f32 v25, v146, v147
    v_cvt_pk_bf16_f32 v26, v156, v157
    v_mfma_f32_16x16x32_bf16 v[128:131], v[64:67], v[80:83], v[128:131]
    v_cvt_pk_bf16_f32 v27, v158, v159
    v_xor_b32 v20, 32, v18
    v_mfma_f32_16x16x32_bf16 v[132:135], v[64:67], v[84:87], v[132:135]
    ds_write_b64 v18, v[24:25] offset:4096
    ds_write_b64 v20, v[26:27] offset:4096
    v_mfma_f32_16x16x32_bf16 v[136:139], v[64:67], v[88:91], v[136:139]
    s_waitcnt lgkmcnt(0)
    v_mfma_f32_16x16x32_bf16 v[92:95], v[36:39], v[68:71], v[92:95]
    v_mfma_f32_16x16x32_bf16 v[96:99], v[36:39], v[72:75], v[96:99]
    s_barrier
    v_mfma_f32_16x16x32_bf16 v[100:103], v[36:39], v[76:79], v[100:103]
    ds_read_b64_tr_b16 v[52:53], v11 offset:49152
    ds_read_b64_tr_b16 v[54:55], v11 offset:51200
    v_mfma_f32_16x16x32_bf16 v[104:107], v[40:43], v[68:71], v[104:107]
    ds_read_b64_tr_b16 v[56:57], v12 offset:49152
    ds_read_b64_tr_b16 v[58:59], v12 offset:51200
    v_mfma_f32_16x16x32_bf16 v[108:111], v[40:43], v[72:75], v[108:111]
    ds_read_b64_tr_b16 v[60:61], v11 offset:49408
    ds_read_b64_tr_b16 v[62:63], v11 offset:51456
    v_mfma_f32_16x16x32_bf16 v[112:115], v[40:43], v[76:79], v[112:115]
    ds_read_b64_tr_b16 v[64:65], v12 offset:49408
    ds_read_b64_tr_b16 v[66:67], v12 offset:51456
    v_mfma_f32_16x16x32_bf16 v[116:119], v[44:47], v[68:71], v[116:119]
    ds_read_b128 v[80:83], v16 offset:0
    ds_read_b128 v[84:87], v16 offset:8192
    v_mfma_f32_16x16x32_bf16 v[120:123], v[44:47], v[72:75], v[120:123]
    ds_read_b128 v[88:91], v16 offset:16384
    v_cvt_pk_bf16_f32 v24, v148, v149
    v_mfma_f32_16x16x32_bf16 v[124:127], v[44:47], v[76:79], v[124:127]
    v_cvt_pk_bf16_f32 v25, v150, v151
    v_cvt_pk_bf16_f32 v26, v160, v161
    v_mfma_f32_16x16x32_bf16 v[128:131], v[48:51], v[68:71], v[128:131]
    v_cvt_pk_bf16_f32 v27, v162, v163
    v_xor_b32 v20, 32, v18
    v_mfma_f32_16x16x32_bf16 v[132:135], v[48:51], v[72:75], v[132:135]
    ds_write_b64 v18, v[24:25] offset:8192
    ds_write_b64 v20, v[26:27] offset:8192
    v_mfma_f32_16x16x32_bf16 v[136:139], v[48:51], v[76:79], v[136:139]
    s_waitcnt lgkmcnt(0)
    v_mfma_f32_16x16x32_bf16 v[92:95], v[52:55], v[80:83], v[92:95]
    v_mfma_f32_16x16x32_bf16 v[96:99], v[52:55], v[84:87], v[96:99]
    s_barrier
    v_mfma_f32_16x16x32_bf16 v[100:103], v[52:55], v[88:91], v[100:103]
    ds_read_b64_tr_b16 v[36:37], v11 offset:0
    ds_read_b64_tr_b16 v[38:39], v11 offset:2048
    v_mfma_f32_16x16x32_bf16 v[104:107], v[56:59], v[80:83], v[104:107]
    ds_read_b64_tr_b16 v[40:41], v12 offset:0
    ds_read_b64_tr_b16 v[42:43], v12 offset:2048
    v_mfma_f32_16x16x32_bf16 v[108:111], v[56:59], v[84:87], v[108:111]
    ds_read_b64_tr_b16 v[44:45], v11 offset:256
    ds_read_b64_tr_b16 v[46:47], v11 offset:2304
    v_mfma_f32_16x16x32_bf16 v[112:115], v[56:59], v[88:91], v[112:115]
    ds_read_b64_tr_b16 v[48:49], v12 offset:256
    ds_read_b64_tr_b16 v[50:51], v12 offset:2304
    v_mfma_f32_16x16x32_bf16 v[116:119], v[60:63], v[80:83], v[116:119]
    ds_read_b128 v[68:71], v13 offset:256
    ds_read_b128 v[72:75], v13 offset:8448
    v_mfma_f32_16x16x32_bf16 v[120:123], v[60:63], v[84:87], v[120:123]
    ds_read_b128 v[76:79], v13 offset:16640
    v_mfma_f32_16x16x32_bf16 v[124:127], v[60:63], v[88:91], v[124:127]
    v_mfma_f32_16x16x32_bf16 v[128:131], v[64:67], v[80:83], v[128:131]
    v_mfma_f32_16x16x32_bf16 v[132:135], v[64:67], v[84:87], v[132:135]
    v_mfma_f32_16x16x32_bf16 v[136:139], v[64:67], v[88:91], v[136:139]
    s_waitcnt lgkmcnt(0)
    v_mfma_f32_16x16x32_bf16 v[92:95], v[36:39], v[68:71], v[92:95]
    v_mfma_f32_16x16x32_bf16 v[96:99], v[36:39], v[72:75], v[96:99]
    s_barrier
    v_mfma_f32_16x16x32_bf16 v[100:103], v[36:39], v[76:79], v[100:103]
    ds_read_b64_tr_b16 v[52:53], v11 offset:16384
    ds_read_b64_tr_b16 v[54:55], v11 offset:18432
    v_mfma_f32_16x16x32_bf16 v[104:107], v[40:43], v[68:71], v[104:107]
    ds_read_b64_tr_b16 v[56:57], v12 offset:16384
    ds_read_b64_tr_b16 v[58:59], v12 offset:18432
    v_mfma_f32_16x16x32_bf16 v[108:111], v[40:43], v[72:75], v[108:111]
    ds_read_b64_tr_b16 v[60:61], v11 offset:16640
    ds_read_b64_tr_b16 v[62:63], v11 offset:18688
    v_mfma_f32_16x16x32_bf16 v[112:115], v[40:43], v[76:79], v[112:115]
    ds_read_b64_tr_b16 v[64:65], v12 offset:16640
    ds_read_b64_tr_b16 v[66:67], v12 offset:18688
    v_mfma_f32_16x16x32_bf16 v[116:119], v[44:47], v[68:71], v[116:119]
    ds_read_b128 v[80:83], v14 offset:256
    ds_read_b128 v[84:87], v14 offset:8448
    v_mfma_f32_16x16x32_bf16 v[120:123], v[44:47], v[72:75], v[120:123]
    ds_read_b128 v[88:91], v14 offset:16640
    v_mfma_f32_16x16x32_bf16 v[124:127], v[44:47], v[76:79], v[124:127]
    v_mfma_f32_16x16x32_bf16 v[128:131], v[48:51], v[68:71], v[128:131]
    v_mfma_f32_16x16x32_bf16 v[132:135], v[48:51], v[72:75], v[132:135]
    v_mfma_f32_16x16x32_bf16 v[136:139], v[48:51], v[76:79], v[136:139]
    s_waitcnt lgkmcnt(0)
    v_mfma_f32_16x16x32_bf16 v[92:95], v[52:55], v[80:83], v[92:95]
    v_mfma_f32_16x16x32_bf16 v[96:99], v[52:55], v[84:87], v[96:99]
    s_barrier
    v_mfma_f32_16x16x32_bf16 v[100:103], v[52:55], v[88:91], v[100:103]
    ds_read_b64_tr_b16 v[36:37], v11 offset:32768
    ds_read_b64_tr_b16 v[38:39], v11 offset:34816
    v_mfma_f32_16x16x32_bf16 v[104:107], v[56:59], v[80:83], v[104:107]
    ds_read_b64_tr_b16 v[40:41], v12 offset:32768
    ds_read_b64_tr_b16 v[42:43], v12 offset:34816
    v_mfma_f32_16x16x32_bf16 v[108:111], v[56:59], v[84:87], v[108:111]
    ds_read_b64_tr_b16 v[44:45], v11 offset:33024
    ds_read_b64_tr_b16 v[46:47], v11 offset:35072
    v_mfma_f32_16x16x32_bf16 v[112:115], v[56:59], v[88:91], v[112:115]
    ds_read_b64_tr_b16 v[48:49], v12 offset:33024
    ds_read_b64_tr_b16 v[50:51], v12 offset:35072
    v_mfma_f32_16x16x32_bf16 v[116:119], v[60:63], v[80:83], v[116:119]
    ds_read_b128 v[68:71], v15 offset:256
    ds_read_b128 v[72:75], v15 offset:8448
    v_mfma_f32_16x16x32_bf16 v[120:123], v[60:63], v[84:87], v[120:123]
    ds_read_b128 v[76:79], v15 offset:16640
    v_mfma_f32_16x16x32_bf16 v[124:127], v[60:63], v[88:91], v[124:127]
    v_mfma_f32_16x16x32_bf16 v[128:131], v[64:67], v[80:83], v[128:131]
    v_mfma_f32_16x16x32_bf16 v[132:135], v[64:67], v[84:87], v[132:135]
    v_mfma_f32_16x16x32_bf16 v[136:139], v[64:67], v[88:91], v[136:139]
    s_waitcnt lgkmcnt(0)
    v_mfma_f32_16x16x32_bf16 v[92:95], v[36:39], v[68:71], v[92:95]
    v_mfma_f32_16x16x32_bf16 v[96:99], v[36:39], v[72:75], v[96:99]
    s_barrier
    v_mfma_f32_16x16x32_bf16 v[100:103], v[36:39], v[76:79], v[100:103]
    ds_read_b64_tr_b16 v[52:53], v11 offset:49152
    ds_read_b64_tr_b16 v[54:55], v11 offset:51200
    v_mfma_f32_16x16x32_bf16 v[104:107], v[40:43], v[68:71], v[104:107]
    ds_read_b64_tr_b16 v[56:57], v12 offset:49152
    ds_read_b64_tr_b16 v[58:59], v12 offset:51200
    v_mfma_f32_16x16x32_bf16 v[108:111], v[40:43], v[72:75], v[108:111]
    ds_read_b64_tr_b16 v[60:61], v11 offset:49408
    ds_read_b64_tr_b16 v[62:63], v11 offset:51456
    v_mfma_f32_16x16x32_bf16 v[112:115], v[40:43], v[76:79], v[112:115]
    ds_read_b64_tr_b16 v[64:65], v12 offset:49408
    ds_read_b64_tr_b16 v[66:67], v12 offset:51456
    v_mfma_f32_16x16x32_bf16 v[116:119], v[44:47], v[68:71], v[116:119]
    ds_read_b128 v[80:83], v16 offset:256
    ds_read_b128 v[84:87], v16 offset:8448
    v_mfma_f32_16x16x32_bf16 v[120:123], v[44:47], v[72:75], v[120:123]
    ds_read_b128 v[88:91], v16 offset:16640
    v_mfma_f32_16x16x32_bf16 v[124:127], v[44:47], v[76:79], v[124:127]
    v_mfma_f32_16x16x32_bf16 v[128:131], v[48:51], v[68:71], v[128:131]
    v_mfma_f32_16x16x32_bf16 v[132:135], v[48:51], v[72:75], v[132:135]
    v_mfma_f32_16x16x32_bf16 v[136:139], v[48:51], v[76:79], v[136:139]
    s_waitcnt lgkmcnt(0)
    v_mfma_f32_16x16x32_bf16 v[92:95], v[52:55], v[80:83], v[92:95]
    v_mfma_f32_16x16x32_bf16 v[96:99], v[52:55], v[84:87], v[96:99]
    v_mfma_f32_16x16x32_bf16 v[100:103], v[52:55], v[88:91], v[100:103]
    v_mfma_f32_16x16x32_bf16 v[104:107], v[56:59], v[80:83], v[104:107]
    v_mfma_f32_16x16x32_bf16 v[108:111], v[56:59], v[84:87], v[108:111]
    v_mfma_f32_16x16x32_bf16 v[112:115], v[56:59], v[88:91], v[112:115]
    v_mfma_f32_16x16x32_bf16 v[116:119], v[60:63], v[80:83], v[116:119]
    v_mfma_f32_16x16x32_bf16 v[120:123], v[60:63], v[84:87], v[120:123]
    v_mfma_f32_16x16x32_bf16 v[124:127], v[60:63], v[88:91], v[124:127]
    v_mfma_f32_16x16x32_bf16 v[128:131], v[64:67], v[80:83], v[128:131]
    v_mfma_f32_16x16x32_bf16 v[132:135], v[64:67], v[84:87], v[132:135]
    v_mfma_f32_16x16x32_bf16 v[136:139], v[64:67], v[88:91], v[136:139]
    s_nop 7
    s_nop 1
    v_cvt_pk_bf16_f32 v24, v92, v93
    v_cvt_pk_bf16_f32 v25, v94, v95
    v_cvt_pk_bf16_f32 v26, v116, v117
    v_cvt_pk_bf16_f32 v27, v118, v119
    v_cvt_pk_bf16_f32 v28, v104, v105
    v_cvt_pk_bf16_f32 v29, v106, v107
    v_cvt_pk_bf16_f32 v30, v128, v129
    v_cvt_pk_bf16_f32 v31, v130, v131
    s_nop 1
    v_mov_b32_dpp v32, v24 row_ror:8 row_mask:0xf bank_mask:0xf
    v_mov_b32_dpp v33, v25 row_ror:8 row_mask:0xf bank_mask:0xf
    v_mov_b32_dpp v34, v26 row_ror:8 row_mask:0xf bank_mask:0xf
    v_mov_b32_dpp v35, v27 row_ror:8 row_mask:0xf bank_mask:0xf
    v_mov_b32_dpp v24, v28 row_ror:8 row_mask:0xf bank_mask:0xc
    v_mov_b32_dpp v25, v29 row_ror:8 row_mask:0xf bank_mask:0xc
    v_mov_b32_dpp v26, v30 row_ror:8 row_mask:0xf bank_mask:0xc
    v_mov_b32_dpp v27, v31 row_ror:8 row_mask:0xf bank_mask:0xc
    v_mov_b32_dpp v28, v32 quad_perm:[0,1,2,3] row_mask:0xf bank_mask:0x3
    v_mov_b32_dpp v29, v33 quad_perm:[0,1,2,3] row_mask:0xf bank_mask:0x3
    v_mov_b32_dpp v30, v34 quad_perm:[0,1,2,3] row_mask:0xf bank_mask:0x3
    v_mov_b32_dpp v31, v35 quad_perm:[0,1,2,3] row_mask:0xf bank_mask:0x3
    s_mov_b32 s72, 0
    buffer_store_dwordx4 v[24:27], v19, s[52:55], s72 offen offset:0 sc1
    buffer_store_dwordx4 v[28:31], v19, s[52:55], s72 offen offset:3072 sc1
    s_nop 1
    v_cvt_pk_bf16_f32 v24, v96, v97
    v_cvt_pk_bf16_f32 v25, v98, v99
    v_cvt_pk_bf16_f32 v26, v120, v121
    v_cvt_pk_bf16_f32 v27, v122, v123
    v_cvt_pk_bf16_f32 v28, v108, v109
    v_cvt_pk_bf16_f32 v29, v110, v111
    v_cvt_pk_bf16_f32 v30, v132, v133
    v_cvt_pk_bf16_f32 v31, v134, v135
    s_nop 1
    v_mov_b32_dpp v32, v24 row_ror:8 row_mask:0xf bank_mask:0xf
    v_mov_b32_dpp v33, v25 row_ror:8 row_mask:0xf bank_mask:0xf
    v_mov_b32_dpp v34, v26 row_ror:8 row_mask:0xf bank_mask:0xf
    v_mov_b32_dpp v35, v27 row_ror:8 row_mask:0xf bank_mask:0xf
    v_mov_b32_dpp v24, v28 row_ror:8 row_mask:0xf bank_mask:0xc
    v_mov_b32_dpp v25, v29 row_ror:8 row_mask:0xf bank_mask:0xc
    v_mov_b32_dpp v26, v30 row_ror:8 row_mask:0xf bank_mask:0xc
    v_mov_b32_dpp v27, v31 row_ror:8 row_mask:0xf bank_mask:0xc
    v_mov_b32_dpp v28, v32 quad_perm:[0,1,2,3] row_mask:0xf bank_mask:0x3
    v_mov_b32_dpp v29, v33 quad_perm:[0,1,2,3] row_mask:0xf bank_mask:0x3
    v_mov_b32_dpp v30, v34 quad_perm:[0,1,2,3] row_mask:0xf bank_mask:0x3
    v_mov_b32_dpp v31, v35 quad_perm:[0,1,2,3] row_mask:0xf bank_mask:0x3
    s_mov_b32 s72, 6144
    buffer_store_dwordx4 v[24:27], v19, s[52:55], s72 offen offset:0 sc1
    buffer_store_dwordx4 v[28:31], v19, s[52:55], s72 offen offset:3072 sc1
    s_nop 1
    v_cvt_pk_bf16_f32 v24, v100, v101
    v_cvt_pk_bf16_f32 v25, v102, v103
    v_cvt_pk_bf16_f32 v26, v124, v125
    v_cvt_pk_bf16_f32 v27, v126, v127
    v_cvt_pk_bf16_f32 v28, v112, v113
    v_cvt_pk_bf16_f32 v29, v114, v115
    v_cvt_pk_bf16_f32 v30, v136, v137
    v_cvt_pk_bf16_f32 v31, v138, v139
    s_nop 1
    v_mov_b32_dpp v32, v24 row_ror:8 row_mask:0xf bank_mask:0xf
    v_mov_b32_dpp v33, v25 row_ror:8 row_mask:0xf bank_mask:0xf
    v_mov_b32_dpp v34, v26 row_ror:8 row_mask:0xf bank_mask:0xf
    v_mov_b32_dpp v35, v27 row_ror:8 row_mask:0xf bank_mask:0xf
    v_mov_b32_dpp v24, v28 row_ror:8 row_mask:0xf bank_mask:0xc
    v_mov_b32_dpp v25, v29 row_ror:8 row_mask:0xf bank_mask:0xc
    v_mov_b32_dpp v26, v30 row_ror:8 row_mask:0xf bank_mask:0xc
    v_mov_b32_dpp v27, v31 row_ror:8 row_mask:0xf bank_mask:0xc
    v_mov_b32_dpp v28, v32 quad_perm:[0,1,2,3] row_mask:0xf bank_mask:0x3
    v_mov_b32_dpp v29, v33 quad_perm:[0,1,2,3] row_mask:0xf bank_mask:0x3
    v_mov_b32_dpp v30, v34 quad_perm:[0,1,2,3] row_mask:0xf bank_mask:0x3
    v_mov_b32_dpp v31, v35 quad_perm:[0,1,2,3] row_mask:0xf bank_mask:0x3
    s_mov_b32 s72, 12288
    buffer_store_dwordx4 v[24:27], v19, s[52:55], s72 offen offset:0 sc1
    buffer_store_dwordx4 v[28:31], v19, s[52:55], s72 offen offset:3072 sc1
    s_nop 1
    s_endpgm
L_copy_role:
    s_mov_b32 s48, s28
    s_mov_b32 s49, s29
    s_mov_b32 s50, 393216
    s_mov_b32 s51, 0x00020000
    s_cmp_ge_u32 s56, 10
    s_cbranch_scc1 L_copier
    s_sub_u32 s58, s56, 8
    s_lshl_b32 s72, s58, 4
    s_add_u32 s72, s72, 0
    v_lshrrev_b32 v3, 4, v2
    v_add_u32 v3, s72, v3
    v_and_b32 v4, 3, v3
    v_bfe_u32 v5, v3, 3, 1
    v_lshl_or_b32 v4, v5, 2, v4
    v_lshlrev_b32 v4, 1, v4
    v_and_b32 v5, 15, v2
    v_xor_b32 v4, v4, v5
    v_mul_u32_u24 v8, 1536, v3
    v_lshl_add_u32 v8, v4, 4, v8
    v_add_u32 v8, s63, v8
    s_lshl_b32 s72, s58, 4
    s_add_u32 s72, s72, 4
    v_lshrrev_b32 v3, 4, v2
    v_add_u32 v3, s72, v3
    v_and_b32 v4, 3, v3
    v_bfe_u32 v5, v3, 3, 1
    v_lshl_or_b32 v4, v5, 2, v4
    v_lshlrev_b32 v4, 1, v4
    v_and_b32 v5, 15, v2
    v_xor_b32 v4, v4, v5
    v_mul_u32_u24 v9, 1536, v3
    v_lshl_add_u32 v9, v4, 4, v9
    v_add_u32 v9, s63, v9
    s_lshl_b32 s72, s58, 4
    s_add_u32 s72, s72, 8
    v_lshrrev_b32 v3, 4, v2
    v_add_u32 v3, s72, v3
    v_and_b32 v4, 3, v3
    v_bfe_u32 v5, v3, 3, 1
    v_lshl_or_b32 v4, v5, 2, v4
    v_lshlrev_b32 v4, 1, v4
    v_and_b32 v5, 15, v2
    v_xor_b32 v4, v4, v5
    v_mul_u32_u24 v10, 1536, v3
    v_lshl_add_u32 v10, v4, 4, v10
    v_add_u32 v10, s63, v10
    s_lshl_b32 s72, s58, 4
    s_add_u32 s72, s72, 12
    v_lshrrev_b32 v3, 4, v2
    v_add_u32 v3, s72, v3
    v_and_b32 v4, 3, v3
    v_bfe_u32 v5, v3, 3, 1
    v_lshl_or_b32 v4, v5, 2, v4
    v_lshlrev_b32 v4, 1, v4
    v_and_b32 v5, 15, v2
    v_xor_b32 v4, v4, v5
    v_mul_u32_u24 v11, 1536, v3
    v_lshl_add_u32 v11, v4, 4, v11
    v_add_u32 v11, s63, v11
    s_lshl_b32 s72, s58, 4
    s_add_u32 s72, s72, 0
    v_lshrrev_b32 v3, 5, v2
    v_add_u32 v3, s72, v3
    v_and_b32 v4, 3, v3
    v_bfe_u32 v5, v3, 3, 1
    v_lshl_or_b32 v4, v5, 2, v4
    v_lshlrev_b32 v4, 1, v4
    v_and_b32 v5, 31, v2
    v_xor_b32 v4, v4, v5
    v_mul_u32_u24 v12, 1536, v3
    v_lshrrev_b32 v5, 4, v4
    v_add_u32 v5, 1, v5
    v_lshl_add_u32 v12, v5, 9, v12
    v_and_b32 v5, 15, v4
    v_lshl_add_u32 v12, v5, 4, v12
    v_add_u32 v12, s63, v12
    s_lshl_b32 s72, s58, 4
    s_add_u32 s72, s72, 2
    v_lshrrev_b32 v3, 5, v2
    v_add_u32 v3, s72, v3
    v_and_b32 v4, 3, v3
    v_bfe_u32 v5, v3, 3, 1
    v_lshl_or_b32 v4, v5, 2, v4
    v_lshlrev_b32 v4, 1, v4
    v_and_b32 v5, 31, v2
    v_xor_b32 v4, v4, v5
    v_mul_u32_u24 v13, 1536, v3
    v_lshrrev_b32 v5, 4, v4
    v_add_u32 v5, 1, v5
    v_lshl_add_u32 v13, v5, 9, v13
    v_and_b32 v5, 15, v4
    v_lshl_add_u32 v13, v5, 4, v13
    v_add_u32 v13, s63, v13
    s_lshl_b32 s72, s58, 4
    s_add_u32 s72, s72, 4
    v_lshrrev_b32 v3, 5, v2
    v_add_u32 v3, s72, v3
    v_and_b32 v4, 3, v3
    v_bfe_u32 v5, v3, 3, 1
    v_lshl_or_b32 v4, v5, 2, v4
    v_lshlrev_b32 v4, 1, v4
    v_and_b32 v5, 31, v2
    v_xor_b32 v4, v4, v5
    v_mul_u32_u24 v14, 1536, v3
    v_lshrrev_b32 v5, 4, v4
    v_add_u32 v5, 1, v5
    v_lshl_add_u32 v14, v5, 9, v14
    v_and_b32 v5, 15, v4
    v_lshl_add_u32 v14, v5, 4, v14
    v_add_u32 v14, s63, v14
    s_lshl_b32 s72, s58, 4
    s_add_u32 s72, s72, 6
    v_lshrrev_b32 v3, 5, v2
    v_add_u32 v3, s72, v3
    v_and_b32 v4, 3, v3
    v_bfe_u32 v5, v3, 3, 1
    v_lshl_or_b32 v4, v5, 2, v4
    v_lshlrev_b32 v4, 1, v4
    v_and_b32 v5, 31, v2
    v_xor_b32 v4, v4, v5
    v_mul_u32_u24 v15, 1536, v3
    v_lshrrev_b32 v5, 4, v4
    v_add_u32 v5, 1, v5
    v_lshl_add_u32 v15, v5, 9, v15
    v_and_b32 v5, 15, v4
    v_lshl_add_u32 v15, v5, 4, v15
    v_add_u32 v15, s63, v15
    s_lshl_b32 s72, s58, 4
    s_add_u32 s72, s72, 8
    v_lshrrev_b32 v3, 5, v2
    v_add_u32 v3, s72, v3
    v_and_b32 v4, 3, v3
    v_bfe_u32 v5, v3, 3, 1
    v_lshl_or_b32 v4, v5, 2, v4
    v_lshlrev_b32 v4, 1, v4
    v_and_b32 v5, 31, v2
    v_xor_b32 v4, v4, v5
    v_mul_u32_u24 v16, 1536, v3
    v_lshrrev_b32 v5, 4, v4
    v_add_u32 v5, 1, v5
    v_lshl_add_u32 v16, v5, 9, v16
    v_and_b32 v5, 15, v4
    v_lshl_add_u32 v16, v5, 4, v16
    v_add_u32 v16, s63, v16
    s_lshl_b32 s72, s58, 4
    s_add_u32 s72, s72, 10
    v_lshrrev_b32 v3, 5, v2
    v_add_u32 v3, s72, v3
    v_and_b32 v4, 3, v3
    v_bfe_u32 v5, v3, 3, 1
    v_lshl_or_b32 v4, v5, 2, v4
    v_lshlrev_b32 v4, 1, v4
    v_and_b32 v5, 31, v2
    v_xor_b32 v4, v4, v5
    v_mul_u32_u24 v17, 1536, v3
    v_lshrrev_b32 v5, 4, v4
    v_add_u32 v5, 1, v5
    v_lshl_add_u32 v17, v5, 9, v17
    v_and_b32 v5, 15, v4
    v_lshl_add_u32 v17, v5, 4, v17
    v_add_u32 v17, s63, v17
    s_lshl_b32 s72, s58, 4
    s_add_u32 s72, s72, 12
    v_lshrrev_b32 v3, 5, v2
    v_add_u32 v3, s72, v3
    v_and_b32 v4, 3, v3
    v_bfe_u32 v5, v3, 3, 1
    v_lshl_or_b32 v4, v5, 2, v4
    v_lshlrev_b32 v4, 1, v4
    v_and_b32 v5, 31, v2
    v_xor_b32 v4, v4, v5
    v_mul_u32_u24 v18, 1536, v3
    v_lshrrev_b32 v5, 4, v4
    v_add_u32 v5, 1, v5
    v_lshl_add_u32 v18, v5, 9, v18
    v_and_b32 v5, 15, v4
    v_lshl_add_u32 v18, v5, 4, v18
    v_add_u32 v18, s63, v18
    s_lshl_b32 s72, s58, 4
    s_add_u32 s72, s72, 14
    v_lshrrev_b32 v3, 5, v2
    v_add_u32 v3, s72, v3
    v_and_b32 v4, 3, v3
    v_bfe_u32 v5, v3, 3, 1
    v_lshl_or_b32 v4, v5, 2, v4
    v_lshlrev_b32 v4, 1, v4
    v_and_b32 v5, 31, v2
    v_xor_b32 v4, v4, v5
    v_mul_u32_u24 v19, 1536, v3
    v_lshrrev_b32 v5, 4, v4
    v_add_u32 v5, 1, v5
    v_lshl_add_u32 v19, v5, 9, v19
    v_and_b32 v5, 15, v4
    v_lshl_add_u32 v19, v5, 4, v19
    v_add_u32 v19, s63, v19
    s_lshl_b32 s65, s58, 12
    s_lshl_b32 s66, s58, 13
    s_mul_i32 s67, s58, 12288
    s_waitcnt lgkmcnt(0)
    s_barrier
    v_mov_b32 v3, 147468
L_l_sp4:
    ds_read_b32 v4, v3
    s_waitcnt lgkmcnt(0)
    v_readfirstlane_b32 s74, v4
    s_cmp_ge_u32 s74, 8
    s_cbranch_scc0 L_l_sp4
    s_mov_b32 s68, 0
    s_add_u32 s72, s65, 49152
    s_mov_b32 m0, s72
    s_nop 0
    buffer_load_dwordx4 v8, s[48:51], s68 offen lds
    s_add_u32 s72, s65, 50176
    s_mov_b32 m0, s72
    s_nop 0
    buffer_load_dwordx4 v9, s[48:51], s68 offen lds
    s_add_u32 s72, s65, 51200
    s_mov_b32 m0, s72
    s_nop 0
    buffer_load_dwordx4 v10, s[48:51], s68 offen lds
    s_add_u32 s72, s65, 52224
    s_mov_b32 m0, s72
    s_nop 0
    buffer_load_dwordx4 v11, s[48:51], s68 offen lds
    s_mov_b32 s68, 49152
    s_add_u32 s72, s65, 57344
    s_mov_b32 m0, s72
    s_nop 0
    buffer_load_dwordx4 v8, s[48:51], s68 offen lds
    s_add_u32 s72, s65, 58368
    s_mov_b32 m0, s72
    s_nop 0
    buffer_load_dwordx4 v9, s[48:51], s68 offen lds
    s_add_u32 s72, s65, 59392
    s_mov_b32 m0, s72
    s_nop 0
    buffer_load_dwordx4 v10, s[48:51], s68 offen lds
    s_add_u32 s72, s65, 60416
    s_mov_b32 m0, s72
    s_nop 0
    buffer_load_dwordx4 v11, s[48:51], s68 offen lds
    s_mov_b32 s68, 98304
    s_add_u32 s72, s65, 65536
    s_mov_b32 m0, s72
    s_nop 0
    buffer_load_dwordx4 v8, s[48:51], s68 offen lds
    s_add_u32 s72, s65, 66560
    s_mov_b32 m0, s72
    s_nop 0
    buffer_load_dwordx4 v9, s[48:51], s68 offen lds
    s_add_u32 s72, s65, 67584
    s_mov_b32 m0, s72
    s_nop 0
    buffer_load_dwordx4 v10, s[48:51], s68 offen lds
    s_add_u32 s72, s65, 68608
    s_mov_b32 m0, s72
    s_nop 0
    buffer_load_dwordx4 v11, s[48:51], s68 offen lds
    s_mov_b32 s68, 147456
    s_add_u32 s72, s65, 73728
    s_mov_b32 m0, s72
    s_nop 0
    buffer_load_dwordx4 v8, s[48:51], s68 offen lds
    s_add_u32 s72, s65, 74752
    s_mov_b32 m0, s72
    s_nop 0
    buffer_load_dwordx4 v9, s[48:51], s68 offen lds
    s_add_u32 s72, s65, 75776
    s_mov_b32 m0, s72
    s_nop 0
    buffer_load_dwordx4 v10, s[48:51], s68 offen lds
    s_add_u32 s72, s65, 76800
    s_mov_b32 m0, s72
    s_nop 0
    buffer_load_dwordx4 v11, s[48:51], s68 offen lds
    s_mov_b32 s68, 196608
    s_add_u32 s72, s65, 81920
    s_mov_b32 m0, s72
    s_nop 0
    buffer_load_dwordx4 v8, s[48:51], s68 offen lds
    s_add_u32 s72, s65, 82944
    s_mov_b32 m0, s72
    s_nop 0
    buffer_load_dwordx4 v9, s[48:51], s68 offen lds
    s_add_u32 s72, s65, 83968
    s_mov_b32 m0, s72
    s_nop 0
    buffer_load_dwordx4 v10, s[48:51], s68 offen lds
    s_add_u32 s72, s65, 84992
    s_mov_b32 m0, s72
    s_nop 0
    buffer_load_dwordx4 v11, s[48:51], s68 offen lds
    s_mov_b32 s68, 245760
    s_add_u32 s72, s65, 90112
    s_mov_b32 m0, s72
    s_nop 0
    buffer_load_dwordx4 v8, s[48:51], s68 offen lds
    s_add_u32 s72, s65, 91136
    s_mov_b32 m0, s72
    s_nop 0
    buffer_load_dwordx4 v9, s[48:51], s68 offen lds
    s_add_u32 s72, s65, 92160
    s_mov_b32 m0, s72
    s_nop 0
    buffer_load_dwordx4 v10, s[48:51], s68 offen lds
    s_add_u32 s72, s65, 93184
    s_mov_b32 m0, s72
    s_nop 0
    buffer_load_dwordx4 v11, s[48:51], s68 offen lds
    s_mov_b32 s68, 294912
    s_add_u32 s72, s65, 98304
    s_mov_b32 m0, s72
    s_nop 0
    buffer_load_dwordx4 v8, s[48:51], s68 offen lds
    s_add_u32 s72, s65, 99328
    s_mov_b32 m0, s72
    s_nop 0
    buffer_load_dwordx4 v9, s[48:51], s68 offen lds
    s_add_u32 s72, s65, 100352
    s_mov_b32 m0, s72
    s_nop 0
    buffer_load_dwordx4 v10, s[48:51], s68 offen lds
    s_add_u32 s72, s65, 101376
    s_mov_b32 m0, s72
    s_nop 0
    buffer_load_dwordx4 v11, s[48:51], s68 offen lds
    s_mov_b32 s68, 344064
    s_add_u32 s72, s65, 106496
    s_mov_b32 m0, s72
    s_nop 0
    buffer_load_dwordx4 v8, s[48:51], s68 offen lds
    s_add_u32 s72, s65, 107520
    s_mov_b32 m0, s72
    s_nop 0
    buffer_load_dwordx4 v9, s[48:51], s68 offen lds
    s_add_u32 s72, s65, 108544
    s_mov_b32 m0, s72
    s_nop 0
    buffer_load_dwordx4 v10, s[48:51], s68 offen lds
    s_add_u32 s72, s65, 109568
    s_mov_b32 m0, s72
    s_nop 0
    buffer_load_dwordx4 v11, s[48:51], s68 offen lds
    s_waitcnt vmcnt(0)
    s_barrier
    s_barrier
    s_mov_b32 s68, 0
    s_add_u32 s72, s66, 49152
    s_mov_b32 m0, s72
    s_nop 0
    buffer_load_dwordx4 v12, s[48:51], s68 offen lds
    s_add_u32 s72, s66, 50176
    s_mov_b32 m0, s72
    s_nop 0
    buffer_load_dwordx4 v13, s[48:51], s68 offen lds
    s_add_u32 s72, s66, 51200
    s_mov_b32 m0, s72
    s_nop 0
    buffer_load_dwordx4 v14, s[48:51], s68 offen lds
    s_add_u32 s72, s66, 52224
    s_mov_b32 m0, s72
    s_nop 0
    buffer_load_dwordx4 v15, s[48:51], s68 offen lds
    s_add_u32 s72, s66, 53248
    s_mov_b32 m0, s72
    s_nop 0
    buffer_load_dwordx4 v16, s[48:51], s68 offen lds
    s_add_u32 s72, s66, 54272
    s_mov_b32 m0, s72
    s_nop 0
    buffer_load_dwordx4 v17, s[48:51], s68 offen lds
    s_add_u32 s72, s66, 55296
    s_mov_b32 m0, s72
    s_nop 0
    buffer_load_dwordx4 v18, s[48:51], s68 offen lds
    s_add_u32 s72, s66, 56320
    s_mov_b32 m0, s72
    s_nop 0
    buffer_load_dwordx4 v19, s[48:51], s68 offen lds
    s_barrier
    s_mov_b32 s68, 49152
    s_add_u32 s72, s66, 65536
    s_mov_b32 m0, s72
    s_nop 0
    buffer_load_dwordx4 v12, s[48:51], s68 offen lds
    s_add_u32 s72, s66, 66560
    s_mov_b32 m0, s72
    s_nop 0
    buffer_load_dwordx4 v13, s[48:51], s68 offen lds
    s_add_u32 s72, s66, 67584
    s_mov_b32 m0, s72
    s_nop 0
    buffer_load_dwordx4 v14, s[48:51], s68 offen lds
    s_add_u32 s72, s66, 68608
    s_mov_b32 m0, s72
    s_nop 0
    buffer_load_dwordx4 v15, s[48:51], s68 offen lds
    s_add_u32 s72, s66, 69632
    s_mov_b32 m0, s72
    s_nop 0
    buffer_load_dwordx4 v16, s[48:51], s68 offen lds
    s_add_u32 s72, s66, 70656
    s_mov_b32 m0, s72
    s_nop 0
    buffer_load_dwordx4 v17, s[48:51], s68 offen lds
    s_add_u32 s72, s66, 71680
    s_mov_b32 m0, s72
    s_nop 0
    buffer_load_dwordx4 v18, s[48:51], s68 offen lds
    s_add_u32 s72, s66, 72704
    s_mov_b32 m0, s72
    s_nop 0
    buffer_load_dwordx4 v19, s[48:51], s68 offen lds
    s_barrier
    s_mov_b32 s68, 98304
    s_add_u32 s72, s66, 81920
    s_mov_b32 m0, s72
    s_nop 0
    buffer_load_dwordx4 v12, s[48:51], s68 offen lds
    s_add_u32 s72, s66, 82944
    s_mov_b32 m0, s72
    s_nop 0
    buffer_load_dwordx4 v13, s[48:51], s68 offen lds
    s_add_u32 s72, s66, 83968
    s_mov_b32 m0, s72
    s_nop 0
    buffer_load_dwordx4 v14, s[48:51], s68 offen lds
    s_add_u32 s72, s66, 84992
    s_mov_b32 m0, s72
    s_nop 0
    buffer_load_dwordx4 v15, s[48:51], s68 offen lds
    s_add_u32 s72, s66, 86016
    s_mov_b32 m0, s72
    s_nop 0
    buffer_load_dwordx4 v16, s[48:51], s68 offen lds
    s_add_u32 s72, s66, 87040
    s_mov_b32 m0, s72
    s_nop 0
    buffer_load_dwordx4 v17, s[48:51], s68 offen lds
    s_add_u32 s72, s66, 88064
    s_mov_b32 m0, s72
    s_nop 0
    buffer_load_dwordx4 v18, s[48:51], s68 offen lds
    s_add_u32 s72, s66, 89088
    s_mov_b32 m0, s72
    s_nop 0
    buffer_load_dwordx4 v19, s[48:51], s68 offen lds
    s_waitcnt vmcnt(16)
    s_barrier
    s_mov_b32 s68, 147456
    s_add_u32 s72, s66, 98304
    s_mov_b32 m0, s72
    s_nop 0
    buffer_load_dwordx4 v12, s[48:51], s68 offen lds
    s_add_u32 s72, s66, 99328
    s_mov_b32 m0, s72
    s_nop 0
    buffer_load_dwordx4 v13, s[48:51], s68 offen lds
    s_add_u32 s72, s66, 100352
    s_mov_b32 m0, s72
    s_nop 0
    buffer_load_dwordx4 v14, s[48:51], s68 offen lds
    s_add_u32 s72, s66, 101376
    s_mov_b32 m0, s72
    s_nop 0
    buffer_load_dwordx4 v15, s[48:51], s68 offen lds
    s_add_u32 s72, s66, 102400
    s_mov_b32 m0, s72
    s_nop 0
    buffer_load_dwordx4 v16, s[48:51], s68 offen lds
    s_add_u32 s72, s66, 103424
    s_mov_b32 m0, s72
    s_nop 0
    buffer_load_dwordx4 v17, s[48:51], s68 offen lds
    s_add_u32 s72, s66, 104448
    s_mov_b32 m0, s72
    s_nop 0
    buffer_load_dwordx4 v18, s[48:51], s68 offen lds
    s_add_u32 s72, s66, 105472
    s_mov_b32 m0, s72
    s_nop 0
    buffer_load_dwordx4 v19, s[48:51], s68 offen lds
    s_waitcnt vmcnt(16)
    s_barrier
    s_mov_b32 s68, 196608
    s_add_u32 s72, s66, 49152
    s_mov_b32 m0, s72
    s_nop 0
    buffer_load_dwordx4 v12, s[48:51], s68 offen lds
    s_add_u32 s72, s66, 50176
    s_mov_b32 m0, s72
    s_nop 0
    buffer_load_dwordx4 v13, s[48:51], s68 offen lds
    s_add_u32 s72, s66, 51200
    s_mov_b32 m0, s72
    s_nop 0
    buffer_load_dwordx4 v14, s[48:51], s68 offen lds
    s_add_u32 s72, s66, 52224
    s_mov_b32 m0, s72
    s_nop 0
    buffer_load_dwordx4 v15, s[48:51], s68 offen lds
    s_add_u32 s72, s66, 53248
    s_mov_b32 m0, s72
    s_nop 0
    buffer_load_dwordx4 v16, s[48:51], s68 offen lds
    s_add_u32 s72, s66, 54272
    s_mov_b32 m0, s72
    s_nop 0
    buffer_load_dwordx4 v17, s[48:51], s68 offen lds
    s_add_u32 s72, s66, 55296
    s_mov_b32 m0, s72
    s_nop 0
    buffer_load_dwordx4 v18, s[48:51], s68 offen lds
    s_add_u32 s72, s66, 56320
    s_mov_b32 m0, s72
    s_nop 0
    buffer_load_dwordx4 v19, s[48:51], s68 offen lds
    s_waitcnt vmcnt(16)
    s_barrier
    s_mov_b32 s68, 245760
    s_add_u32 s72, s66, 65536
    s_mov_b32 m0, s72
    s_nop 0
    buffer_load_dwordx4 v12, s[48:51], s68 offen lds
    s_add_u32 s72, s66, 66560
    s_mov_b32 m0, s72
    s_nop 0
    buffer_load_dwordx4 v13, s[48:51], s68 offen lds
    s_add_u32 s72, s66, 67584
    s_mov_b32 m0, s72
    s_nop 0
    buffer_load_dwordx4 v14, s[48:51], s68 offen lds
    s_add_u32 s72, s66, 68608
    s_mov_b32 m0, s72
    s_nop 0
    buffer_load_dwordx4 v15, s[48:51], s68 offen lds
    s_add_u32 s72, s66, 69632
    s_mov_b32 m0, s72
    s_nop 0
    buffer_load_dwordx4 v16, s[48:51], s68 offen lds
    s_add_u32 s72, s66, 70656
    s_mov_b32 m0, s72
    s_nop 0
    buffer_load_dwordx4 v17, s[48:51], s68 offen lds
    s_add_u32 s72, s66, 71680
    s_mov_b32 m0, s72
    s_nop 0
    buffer_load_dwordx4 v18, s[48:51], s68 offen lds
    s_add_u32 s72, s66, 72704
    s_mov_b32 m0, s72
    s_nop 0
    buffer_load_dwordx4 v19, s[48:51], s68 offen lds
    s_waitcnt vmcnt(16)
    s_barrier
    s_mov_b32 s68, 294912
    s_add_u32 s72, s66, 81920
    s_mov_b32 m0, s72
    s_nop 0
    buffer_load_dwordx4 v12, s[48:51], s68 offen lds
    s_add_u32 s72, s66, 82944
    s_mov_b32 m0, s72
    s_nop 0
    buffer_load_dwordx4 v13, s[48:51], s68 offen lds
    s_add_u32 s72, s66, 83968
    s_mov_b32 m0, s72
    s_nop 0
    buffer_load_dwordx4 v14, s[48:51], s68 offen lds
    s_add_u32 s72, s66, 84992
    s_mov_b32 m0, s72
    s_nop 0
    buffer_load_dwordx4 v15, s[48:51], s68 offen lds
    s_add_u32 s72, s66, 86016
    s_mov_b32 m0, s72
    s_nop 0
    buffer_load_dwordx4 v16, s[48:51], s68 offen lds
    s_add_u32 s72, s66, 87040
    s_mov_b32 m0, s72
    s_nop 0
    buffer_load_dwordx4 v17, s[48:51], s68 offen lds
    s_add_u32 s72, s66, 88064
    s_mov_b32 m0, s72
    s_nop 0
    buffer_load_dwordx4 v18, s[48:51], s68 offen lds
    s_add_u32 s72, s66, 89088
    s_mov_b32 m0, s72
    s_nop 0
    buffer_load_dwordx4 v19, s[48:51], s68 offen lds
    s_waitcnt vmcnt(16)
    s_barrier
    s_mov_b32 s68, 344064
    s_add_u32 s72, s66, 98304
    s_mov_b32 m0, s72
    s_nop 0
    buffer_load_dwordx4 v12, s[48:51], s68 offen lds
    s_add_u32 s72, s66, 99328
    s_mov_b32 m0, s72
    s_nop 0
    buffer_load_dwordx4 v13, s[48:51], s68 offen lds
    s_add_u32 s72, s66, 100352
    s_mov_b32 m0, s72
    s_nop 0
    buffer_load_dwordx4 v14, s[48:51], s68 offen lds
    s_add_u32 s72, s66, 101376
    s_mov_b32 m0, s72
    s_nop 0
    buffer_load_dwordx4 v15, s[48:51], s68 offen lds
    s_add_u32 s72, s66, 102400
    s_mov_b32 m0, s72
    s_nop 0
    buffer_load_dwordx4 v16, s[48:51], s68 offen lds
    s_add_u32 s72, s66, 103424
    s_mov_b32 m0, s72
    s_nop 0
    buffer_load_dwordx4 v17, s[48:51], s68 offen lds
    s_add_u32 s72, s66, 104448
    s_mov_b32 m0, s72
    s_nop 0
    buffer_load_dwordx4 v18, s[48:51], s68 offen lds
    s_add_u32 s72, s66, 105472
    s_mov_b32 m0, s72
    s_nop 0
    buffer_load_dwordx4 v19, s[48:51], s68 offen lds
    s_waitcnt vmcnt(16)
    s_barrier
    s_waitcnt vmcnt(8)
    s_barrier
    s_waitcnt vmcnt(0)
    s_barrier
    s_endpgm
L_copier:
    s_sub_u32 s58, s56, 10
    v_lshrrev_b32 v6, 3, v2
    s_mul_i32 s73, s58, 48
    v_add_u32 v3, s73, v6
    v_and_b32 v7, 7, v2
    v_add_u32 v5, s57, v3
    v_mul_u32_u24 v5, 384, v5
    v_lshl_add_u32 v5, v7, 4, v5
    s_lshl_b32 s71, s60, 1
    s_mul_i32 s71, s71, 3870720
    v_add_u32 v5, s71, v5
    s_waitcnt lgkmcnt(0)
    s_barrier
    v_mov_b32 v10, 147472
L_c_sp:
    ds_read_b32 v11, v10
    s_waitcnt lgkmcnt(0)
    v_readfirstlane_b32 s74, v11
    s_cmp_ge_u32 s74, 8
    s_cbranch_scc0 L_c_sp
    s_lshr_b32 s72, s2, 3
    s_mul_i32 s72, s72, 313
    v_lshrrev_b32 v8, 4, v2
    v_add_u32 v8, s72, v8
    v_lshlrev_b32 v8, 11, v8
    v_bfe_u32 v9, v2, 3, 1
    v_lshl_add_u32 v8, v9, 9, v8
    v_and_b32 v9, 7, v2
    v_lshl_add_u32 v8, v9, 4, v8
    s_and_b32 s72, s2, 1
    s_lshl_b32 s72, s72, 10
    s_bfe_u32 s73, s2, 0x20001
    s_lshl_b32 s73, s73, 7
    s_add_u32 s72, s72, s73
    v_add_u32 v8, s72, v8
    s_add_u32 s72, s58, 0
    s_lshl_b32 s72, s72, 13
    buffer_load_dwordx4 v[64:67], v8, s[40:43], s72 offen
    s_add_u32 s72, s58, 2
    s_lshl_b32 s72, s72, 13
    buffer_load_dwordx4 v[68:71], v8, s[40:43], s72 offen
    s_add_u32 s72, s58, 4
    s_lshl_b32 s72, s72, 13
    buffer_load_dwordx4 v[72:75], v8, s[40:43], s72 offen
    s_add_u32 s72, s58, 6
    s_lshl_b32 s72, s72, 13
    buffer_load_dwordx4 v[76:79], v8, s[40:43], s72 offen
    s_add_u32 s72, s58, 8
    s_lshl_b32 s72, s72, 13
    buffer_load_dwordx4 v[80:83], v8, s[40:43], s72 offen
    s_add_u32 s72, s58, 10
    s_lshl_b32 s72, s72, 13
    buffer_load_dwordx4 v[84:87], v8, s[40:43], s72 offen
    s_add_u32 s72, s58, 12
    s_lshl_b32 s72, s72, 13
    buffer_load_dwordx4 v[88:91], v8, s[40:43], s72 offen
    s_add_u32 s72, s58, 14
    s_lshl_b32 s72, s72, 13
    buffer_load_dwordx4 v[92:95], v8, s[40:43], s72 offen
    s_add_u32 s72, s58, 16
    s_lshl_b32 s72, s72, 13
    buffer_load_dwordx4 v[96:99], v8, s[40:43], s72 offen
    s_add_u32 s72, s58, 18
    s_lshl_b32 s72, s72, 13
    buffer_load_dwordx4 v[100:103], v8, s[40:43], s72 offen
    s_add_u32 s72, s58, 20
    s_lshl_b32 s72, s72, 13
    buffer_load_dwordx4 v[104:107], v8, s[40:43], s72 offen
    s_add_u32 s72, s58, 22
    s_lshl_b32 s72, s72, 13
    buffer_load_dwordx4 v[108:111], v8, s[40:43], s72 offen
    s_add_u32 s72, s58, 24
    s_lshl_b32 s72, s72, 13
    buffer_load_dwordx4 v[64:67], v8, s[40:43], s72 offen
    s_add_u32 s72, s58, 26
    s_lshl_b32 s72, s72, 13
    buffer_load_dwordx4 v[68:71], v8, s[40:43], s72 offen
    s_add_u32 s72, s58, 28
    s_lshl_b32 s72, s72, 13
    buffer_load_dwordx4 v[72:75], v8, s[40:43], s72 offen
    s_add_u32 s72, s58, 30
    s_lshl_b32 s72, s72, 13
    buffer_load_dwordx4 v[76:79], v8, s[40:43], s72 offen
    s_add_u32 s72, s58, 32
    s_lshl_b32 s72, s72, 13
    buffer_load_dwordx4 v[80:83], v8, s[40:43], s72 offen
    s_add_u32 s72, s58, 34
    s_lshl_b32 s72, s72, 13
    buffer_load_dwordx4 v[84:87], v8, s[40:43], s72 offen
    s_add_u32 s72, s58, 36
    s_lshl_b32 s72, s72, 13
    buffer_load_dwordx4 v[88:91], v8, s[40:43], s72 offen
    s_add_u32 s72, s58, 38
    s_lshl_b32 s72, s72, 13
    buffer_load_dwordx4 v[92:95], v8, s[40:43], s72 offen
    s_add_u32 s72, s58, 40
    s_lshl_b32 s72, s72, 13
    buffer_load_dwordx4 v[96:99], v8, s[40:43], s72 offen
    s_add_u32 s72, s58, 42
    s_lshl_b32 s72, s72, 13
    buffer_load_dwordx4 v[100:103], v8, s[40:43], s72 offen
    s_add_u32 s72, s58, 44
    s_lshl_b32 s72, s72, 13
    buffer_load_dwordx4 v[104:107], v8, s[40:43], s72 offen
    s_add_u32 s72, s58, 46
    s_lshl_b32 s72, s72, 13
    buffer_load_dwordx4 v[108:111], v8, s[40:43], s72 offen
    s_add_u32 s72, s58, 48
    s_lshl_b32 s72, s72, 13
    buffer_load_dwordx4 v[64:67], v8, s[40:43], s72 offen
    s_add_u32 s72, s58, 50
    s_lshl_b32 s72, s72, 13
    buffer_load_dwordx4 v[68:71], v8, s[40:43], s72 offen
    s_add_u32 s72, s58, 52
    s_lshl_b32 s72, s72, 13
    buffer_load_dwordx4 v[72:75], v8, s[40:43], s72 offen
    s_add_u32 s72, s58, 54
    s_lshl_b32 s72, s72, 13
    buffer_load_dwordx4 v[76:79], v8, s[40:43], s72 offen
    s_add_u32 s72, s58, 56
    s_lshl_b32 s72, s72, 13
    buffer_load_dwordx4 v[80:83], v8, s[40:43], s72 offen
    s_add_u32 s72, s58, 58
    s_lshl_b32 s72, s72, 13
    buffer_load_dwordx4 v[84:87], v8, s[40:43], s72 offen
    s_add_u32 s72, s58, 60
    s_lshl_b32 s72, s72, 13
    buffer_load_dwordx4 v[88:91], v8, s[40:43], s72 offen
    s_add_u32 s72, s58, 62
    s_lshl_b32 s72, s72, 13
    buffer_load_dwordx4 v[92:95], v8, s[40:43], s72 offen
    s_add_u32 s72, s58, 64
    s_lshl_b32 s72, s72, 13
    buffer_load_dwordx4 v[96:99], v8, s[40:43], s72 offen
    s_add_u32 s72, s58, 66
    s_lshl_b32 s72, s72, 13
    buffer_load_dwordx4 v[100:103], v8, s[40:43], s72 offen
    s_add_u32 s72, s58, 68
    s_lshl_b32 s72, s72, 13
    buffer_load_dwordx4 v[104:107], v8, s[40:43], s72 offen
    s_add_u32 s72, s58, 70
    s_lshl_b32 s72, s72, 13
    buffer_load_dwordx4 v[108:111], v8, s[40:43], s72 offen
    s_add_u32 s72, s58, 72
    s_lshl_b32 s72, s72, 13
    buffer_load_dwordx4 v[64:67], v8, s[40:43], s72 offen
    s_add_u32 s72, s58, 74
    s_lshl_b32 s72, s72, 13
    buffer_load_dwordx4 v[68:71], v8, s[40:43], s72 offen
    s_add_u32 s72, s58, 76
    s_lshl_b32 s72, s72, 13
    buffer_load_dwordx4 v[72:75], v8, s[40:43], s72 offen
    s_add_u32 s72, s58, 78
    s_cmp_ge_u32 s72, 79
    s_cbranch_scc1 L_l2pf_64_2
    s_lshl_b32 s72, s72, 13
    buffer_load_dwordx4 v[76:79], v8, s[40:43], s72 offen
L_l2pf_64_2:
    s_barrier
    s_barrier
    s_barrier
    s_barrier
    s_barrier
    s_barrier
    s_barrier
    s_barrier
    s_barrier
    v_add_u32 v8, 0, v3
    v_and_b32 v9, 15, v8
    v_add_u32 v10, 0, v7
    v_xor_b32 v9, v9, v10
    v_lshlrev_b32 v9, 4, v9
    v_lshl_add_u32 v9, v8, 8, v9
    v_add_u32 v9, 114688, v9
    ds_read_b128 v[16:19], v9
    v_add_u32 v8, 0, v3
    v_and_b32 v9, 15, v8
    v_add_u32 v10, 8, v7
    v_xor_b32 v9, v9, v10
    v_lshlrev_b32 v9, 4, v9
    v_lshl_add_u32 v9, v8, 8, v9
    v_add_u32 v9, 114688, v9
    ds_read_b128 v[20:23], v9
    v_add_u32 v8, 8, v3
    v_and_b32 v9, 15, v8
    v_add_u32 v10, 0, v7
    v_xor_b32 v9, v9, v10
    v_lshlrev_b32 v9, 4, v9
    v_lshl_add_u32 v9, v8, 8, v9
    v_add_u32 v9, 114688, v9
    ds_read_b128 v[24:27], v9
    v_add_u32 v8, 8, v3
    v_and_b32 v9, 15, v8
    v_add_u32 v10, 8, v7
    v_xor_b32 v9, v9, v10
    v_lshlrev_b32 v9, 4, v9
    v_lshl_add_u32 v9, v8, 8, v9
    v_add_u32 v9, 114688, v9
    ds_read_b128 v[28:31], v9
    s_waitcnt lgkmcnt(3)
    s_mov_b32 s72, 0
    buffer_store_dwordx4 v[16:19], v5, s[52:55], s72 offen offset:256 sc1
    s_waitcnt lgkmcnt(2)
    s_mov_b32 s72, 3870720
    buffer_store_dwordx4 v[20:23], v5, s[52:55], s72 offen offset:256 sc1
    s_waitcnt lgkmcnt(1)
    s_mov_b32 s72, 3072
    buffer_store_dwordx4 v[24:27], v5, s[52:55], s72 offen offset:256 sc1
    s_waitcnt lgkmcnt(0)
    s_mov_b32 s72, 3873792
    buffer_store_dwordx4 v[28:31], v5, s[52:55], s72 offen offset:256 sc1
    s_barrier
    v_add_u32 v8, 16, v3
    v_and_b32 v9, 15, v8
    v_add_u32 v10, 0, v7
    v_xor_b32 v9, v9, v10
    v_lshlrev_b32 v9, 4, v9
    v_lshl_add_u32 v9, v8, 8, v9
    v_add_u32 v9, 114688, v9
    ds_read_b128 v[32:35], v9
    v_add_u32 v8, 16, v3
    v_and_b32 v9, 15, v8
    v_add_u32 v10, 8, v7
    v_xor_b32 v9, v9, v10
    v_lshlrev_b32 v9, 4, v9
    v_lshl_add_u32 v9, v8, 8, v9
    v_add_u32 v9, 114688, v9
    ds_read_b128 v[36:39], v9
    v_add_u32 v8, 24, v3
    v_and_b32 v9, 15, v8
    v_add_u32 v10, 0, v7
    v_xor_b32 v9, v9, v10
    v_lshlrev_b32 v9, 4, v9
    v_lshl_add_u32 v9, v8, 8, v9
    v_add_u32 v9, 114688, v9
    ds_read_b128 v[40:43], v9
    v_add_u32 v8, 24, v3
    v_and_b32 v9, 15, v8
    v_add_u32 v10, 8, v7
    v_xor_b32 v9, v9, v10
    v_lshlrev_b32 v9, 4, v9
    v_lshl_add_u32 v9, v8, 8, v9
    v_add_u32 v9, 114688, v9
    ds_read_b128 v[44:47], v9
    s_waitcnt lgkmcnt(3)
    s_mov_b32 s72, 6144
    buffer_store_dwordx4 v[32:35], v5, s[52:55], s72 offen offset:256 sc1
    s_waitcnt lgkmcnt(2)
    s_mov_b32 s72, 3876864
    buffer_store_dwordx4 v[36:39], v5, s[52:55], s72 offen offset:256 sc1
    s_waitcnt lgkmcnt(1)
    s_mov_b32 s72, 9216
    buffer_store_dwordx4 v[40:43], v5, s[52:55], s72 offen offset:256 sc1
    s_waitcnt lgkmcnt(0)
    s_mov_b32 s72, 3879936
    buffer_store_dwordx4 v[44:47], v5, s[52:55], s72 offen offset:256 sc1
    s_barrier
    v_add_u32 v8, 32, v3
    v_and_b32 v9, 15, v8
    v_add_u32 v10, 0, v7
    v_xor_b32 v9, v9, v10
    v_lshlrev_b32 v9, 4, v9
    v_lshl_add_u32 v9, v8, 8, v9
    v_add_u32 v9, 114688, v9
    ds_read_b128 v[48:51], v9
    v_add_u32 v8, 32, v3
    v_and_b32 v9, 15, v8
    v_add_u32 v10, 8, v7
    v_xor_b32 v9, v9, v10
    v_lshlrev_b32 v9, 4, v9
    v_lshl_add_u32 v9, v8, 8, v9
    v_add_u32 v9, 114688, v9
    ds_read_b128 v[52:55], v9
    v_add_u32 v8, 40, v3
    v_and_b32 v9, 15, v8
    v_add_u32 v10, 0, v7
    v_xor_b32 v9, v9, v10
    v_lshlrev_b32 v9, 4, v9
    v_lshl_add_u32 v9, v8, 8, v9
    v_add_u32 v9, 114688, v9
    ds_read_b128 v[56:59], v9
    v_add_u32 v8, 40, v3
    v_and_b32 v9, 15, v8
    v_add_u32 v10, 8, v7
    v_xor_b32 v9, v9, v10
    v_lshlrev_b32 v9, 4, v9
    v_lshl_add_u32 v9, v8, 8, v9
    v_add_u32 v9, 114688, v9
    ds_read_b128 v[60:63], v9
    s_waitcnt lgkmcnt(3)
    s_mov_b32 s72, 12288
    buffer_store_dwordx4 v[48:51], v5, s[52:55], s72 offen offset:256 sc1
    s_waitcnt lgkmcnt(2)
    s_mov_b32 s72, 3883008
    buffer_store_dwordx4 v[52:55], v5, s[52:55], s72 offen offset:256 sc1
    s_waitcnt lgkmcnt(1)
    s_mov_b32 s72, 15360
    buffer_store_dwordx4 v[56:59], v5, s[52:55], s72 offen offset:256 sc1
    s_waitcnt lgkmcnt(0)
    s_mov_b32 s72, 3886080
    buffer_store_dwordx4 v[60:63], v5, s[52:55], s72 offen offset:256 sc1
    s_barrier
    s_endpgm
L_k1_edge:
    v_lshrrev_b32 v1, 6, v0
    v_and_b32 v2, 63, v0
    s_waitcnt lgkmcnt(0)
    v_readfirstlane_b32 s64, v1
    s_load_dwordx2 s[66:67], s[24:25], 0
    s_mov_b32 s40, s18
    s_mov_b32 s41, s19
    s_mov_b32 s42, 60000
    s_mov_b32 s43, 0x00020000
    s_mov_b32 s44, s20
    s_mov_b32 s45, s21
    s_mov_b32 s46, 640000
    s_mov_b32 s47, 0x00020000
    s_mov_b32 s48, s22
    s_mov_b32 s49, s23
    s_mov_b32 s50, 640000
    s_mov_b32 s51, 0x00020000
    s_mov_b32 s52, s34
    s_mov_b32 s53, s35
    s_mov_b32 s54, 256
    s_mov_b32 s55, 0x00020000
    s_add_u32 s56, s36, 31000064
    s_addc_u32 s57, s37, 0
    s_mov_b32 s58, 10240
    s_mov_b32 s59, 0x00020000
    s_add_u32 s60, s36, 33554432
    s_addc_u32 s61, s37, 0
    s_mov_b32 s62, 103055360
    s_mov_b32 s63, 0x00020000
    s_mul_i32 s65, s2, 16000
    v_lshlrev_b32 v3, 5, v0
    v_add_u32 v3, s65, v3
    v_cmp_gt_u32 vcc, 500, v0
    s_and_saveexec_b64 s[72:73], vcc
    s_cbranch_execz L_e_noload
    buffer_load_dwordx4 v[8:11], v3, s[44:47], 0 offen
    buffer_load_dwordx4 v[12:15], v3, s[44:47], 0 offen offset:16
    buffer_load_dwordx4 v[16:19], v3, s[48:51], 0 offen
    buffer_load_dwordx4 v[20:23], v3, s[48:51], 0 offen offset:16
L_e_noload:
    s_mov_b64 exec, s[72:73]
    v_lshlrev_b32 v4, 4, v2
    s_cmp_ge_u32 s64, 8
    s_cbranch_scc1 L_e_pf
    s_lshl_b32 s65, s64, 13
    s_add_u32 s65, s65, 0
    s_add_u32 s78, s65, 33792
    s_mov_b32 m0, s78
    s_nop 0
    buffer_load_dwordx4 v4, s[40:43], s65 offen  lds
    s_lshl_b32 s65, s64, 13
    s_add_u32 s65, s65, 1024
    s_add_u32 s78, s65, 33792
    s_mov_b32 m0, s78
    s_nop 0
    buffer_load_dwordx4 v4, s[40:43], s65 offen  lds
    s_lshl_b32 s65, s64, 13
    s_add_u32 s65, s65, 2048
    s_add_u32 s78, s65, 33792
    s_mov_b32 m0, s78
    s_nop 0
    buffer_load_dwordx4 v4, s[40:43], s65 offen  lds
    s_lshl_b32 s65, s64, 13
    s_add_u32 s65, s65, 3072
    s_add_u32 s78, s65, 33792
    s_mov_b32 m0, s78
    s_nop 0
    buffer_load_dwordx4 v4, s[40:43], s65 offen  lds
    s_lshl_b32 s65, s64, 13
    s_add_u32 s65, s65, 4096
    s_add_u32 s78, s65, 33792
    s_mov_b32 m0, s78
    s_nop 0
    buffer_load_dwordx4 v4, s[40:43], s65 offen  lds
    s_lshl_b32 s65, s64, 13
    s_add_u32 s65, s65, 5120
    s_add_u32 s78, s65, 33792
    s_mov_b32 m0, s78
    s_nop 0
    buffer_load_dwordx4 v4, s[40:43], s65 offen  lds
    s_lshl_b32 s65, s64, 13
    s_add_u32 s65, s65, 6144
    s_add_u32 s78, s65, 33792
    s_mov_b32 m0, s78
    s_nop 0
    buffer_load_dwordx4 v4, s[40:43], s65 offen  lds
    s_lshl_b32 s65, s64, 13
    s_add_u32 s65, s65, 7168
    s_add_u32 s78, s65, 33792
    s_mov_b32 m0, s78
    s_nop 0
    buffer_load_dwordx4 v4, s[40:43], s65 offen  lds
    s_branch L_e_nopos
L_e_pf:
    s_mov_b32 s80, s16
    s_mov_b32 s81, s17
    s_mov_b32 s82, 20480000
    s_mov_b32 s83, 0x00020000
    s_sub_u32 s79, s64, 8
    s_lshr_b32 s72, s2, 3
    s_mul_i32 s72, s72, 313
    v_lshrrev_b32 v8, 4, v2
    v_add_u32 v8, s72, v8
    v_lshlrev_b32 v8, 11, v8
    v_bfe_u32 v9, v2, 3, 1
    v_lshl_add_u32 v8, v9, 9, v8
    v_and_b32 v9, 7, v2
    v_lshl_add_u32 v8, v9, 4, v8
    s_and_b32 s72, s2, 1
    s_lshl_b32 s72, s72, 10
    s_bfe_u32 s73, s2, 0x20001
    s_lshl_b32 s73, s73, 7
    s_add_u32 s72, s72, s73
    v_add_u32 v8, s72, v8
    s_add_u32 s72, s79, 0
    s_lshl_b32 s72, s72, 13
    buffer_load_dwordx4 v[112:115], v8, s[80:83], s72 offen
    s_add_u32 s72, s79, 4
    s_lshl_b32 s72, s72, 13
    buffer_load_dwordx4 v[116:119], v8, s[80:83], s72 offen
    s_add_u32 s72, s79, 8
    s_lshl_b32 s72, s72, 13
    buffer_load_dwordx4 v[120:123], v8, s[80:83], s72 offen
    s_add_u32 s72, s79, 12
    s_lshl_b32 s72, s72, 13
    buffer_load_dwordx4 v[124:127], v8, s[80:83], s72 offen
    s_add_u32 s72, s79, 16
    s_lshl_b32 s72, s72, 13
    buffer_load_dwordx4 v[128:131], v8, s[80:83], s72 offen
    s_add_u32 s72, s79, 20
    s_lshl_b32 s72, s72, 13
    buffer_load_dwordx4 v[132:135], v8, s[80:83], s72 offen
    s_add_u32 s72, s79, 24
    s_lshl_b32 s72, s72, 13
    buffer_load_dwordx4 v[136:139], v8, s[80:83], s72 offen
    s_add_u32 s72, s79, 28
    s_lshl_b32 s72, s72, 13
    buffer_load_dwordx4 v[140:143], v8, s[80:83], s72 offen
    s_add_u32 s72, s79, 32
    s_lshl_b32 s72, s72, 13
    buffer_load_dwordx4 v[144:147], v8, s[80:83], s72 offen
    s_add_u32 s72, s79, 36
    s_lshl_b32 s72, s72, 13
    buffer_load_dwordx4 v[148:151], v8, s[80:83], s72 offen
    s_add_u32 s72, s79, 40
    s_lshl_b32 s72, s72, 13
    buffer_load_dwordx4 v[152:155], v8, s[80:83], s72 offen
    s_add_u32 s72, s79, 44
    s_lshl_b32 s72, s72, 13
    buffer_load_dwordx4 v[156:159], v8, s[80:83], s72 offen
    s_add_u32 s72, s79, 48
    s_lshl_b32 s72, s72, 13
    buffer_load_dwordx4 v[112:115], v8, s[80:83], s72 offen
    s_add_u32 s72, s79, 52
    s_lshl_b32 s72, s72, 13
    buffer_load_dwordx4 v[116:119], v8, s[80:83], s72 offen
    s_add_u32 s72, s79, 56
    s_lshl_b32 s72, s72, 13
    buffer_load_dwordx4 v[120:123], v8, s[80:83], s72 offen
    s_add_u32 s72, s79, 60
    s_lshl_b32 s72, s72, 13
    buffer_load_dwordx4 v[124:127], v8, s[80:83], s72 offen
    s_add_u32 s72, s79, 64
    s_lshl_b32 s72, s72, 13
    buffer_load_dwordx4 v[128:131], v8, s[80:83], s72 offen
    s_add_u32 s72, s79, 68
    s_lshl_b32 s72, s72, 13
    buffer_load_dwordx4 v[132:135], v8, s[80:83], s72 offen
    s_add_u32 s72, s79, 72
    s_lshl_b32 s72, s72, 13
    buffer_load_dwordx4 v[136:139], v8, s[80:83], s72 offen
    s_add_u32 s72, s79, 76
    s_cmp_ge_u32 s72, 79
    s_cbranch_scc1 L_l2pf_112_4
    s_lshl_b32 s72, s72, 13
    buffer_load_dwordx4 v[140:143], v8, s[80:83], s72 offen
L_l2pf_112_4:
L_e_nopos:
    s_cmp_eq_u32 s64, 0
    s_cbranch_scc0 L_e_nozero
    v_mov_b32 v5, 0
    v_lshlrev_b32 v6, 2, v2
    ds_write_b32 v6, v5 offset:0
    v_mov_b32 v6, 512
    ds_write_b32 v6, v5
L_e_nozero:
    s_waitcnt vmcnt(0) lgkmcnt(0)
    s_lshl_b32 s68, s66, 16
    s_and_b32 s69, s66, 0xffff0000
    s_lshl_b32 s70, s67, 16
    s_and_b32 s71, s67, 0xffff0000
    s_waitcnt lgkmcnt(0)
    s_barrier
    v_cmp_gt_u32 vcc, 500, v0
    s_and_saveexec_b64 s[72:73], vcc
    s_cbranch_execz L_e_pass1_done
    v_mul_u32_u24 v24, 6, v8
    v_and_b32 v24, -4, v24
    v_add_u32 v24, 33792, v24
    v_and_b32 v40, 1, v8
    v_lshlrev_b32 v40, 4, v40
    v_mul_u32_u24 v25, 6, v16
    v_and_b32 v25, -4, v25
    v_add_u32 v25, 33792, v25
    v_and_b32 v41, 1, v16
    v_lshlrev_b32 v41, 4, v41
    v_mul_u32_u24 v26, 6, v9
    v_and_b32 v26, -4, v26
    v_add_u32 v26, 33792, v26
    v_and_b32 v42, 1, v9
    v_lshlrev_b32 v42, 4, v42
    v_mul_u32_u24 v27, 6, v17
    v_and_b32 v27, -4, v27
    v_add_u32 v27, 33792, v27
    v_and_b32 v43, 1, v17
    v_lshlrev_b32 v43, 4, v43
    v_mul_u32_u24 v28, 6, v10
    v_and_b32 v28, -4, v28
    v_add_u32 v28, 33792, v28
    v_and_b32 v44, 1, v10
    v_lshlrev_b32 v44, 4, v44
    v_mul_u32_u24 v29, 6, v18
    v_and_b32 v29, -4, v29
    v_add_u32 v29, 33792, v29
    v_and_b32 v45, 1, v18
    v_lshlrev_b32 v45, 4, v45
    v_mul_u32_u24 v30, 6, v11
    v_and_b32 v30, -4, v30
    v_add_u32 v30, 33792, v30
    v_and_b32 v46, 1, v11
    v_lshlrev_b32 v46, 4, v46
    v_mul_u32_u24 v31, 6, v19
    v_and_b32 v31, -4, v31
    v_add_u32 v31, 33792, v31
    v_and_b32 v47, 1, v19
    v_lshlrev_b32 v47, 4, v47
    v_mul_u32_u24 v32, 6, v12
    v_and_b32 v32, -4, v32
    v_add_u32 v32, 33792, v32
    v_and_b32 v48, 1, v12
    v_lshlrev_b32 v48, 4, v48
    v_mul_u32_u24 v33, 6, v20
    v_and_b32 v33, -4, v33
    v_add_u32 v33, 33792, v33
    v_and_b32 v49, 1, v20
    v_lshlrev_b32 v49, 4, v49
    v_mul_u32_u24 v34, 6, v13
    v_and_b32 v34, -4, v34
    v_add_u32 v34, 33792, v34
    v_and_b32 v50, 1, v13
    v_lshlrev_b32 v50, 4, v50
    v_mul_u32_u24 v35, 6, v21
    v_and_b32 v35, -4, v35
    v_add_u32 v35, 33792, v35
    v_and_b32 v51, 1, v21
    v_lshlrev_b32 v51, 4, v51
    v_mul_u32_u24 v36, 6, v14
    v_and_b32 v36, -4, v36
    v_add_u32 v36, 33792, v36
    v_and_b32 v52, 1, v14
    v_lshlrev_b32 v52, 4, v52
    v_mul_u32_u24 v37, 6, v22
    v_and_b32 v37, -4, v37
    v_add_u32 v37, 33792, v37
    v_and_b32 v53, 1, v22
    v_lshlrev_b32 v53, 4, v53
    v_mul_u32_u24 v38, 6, v15
    v_and_b32 v38, -4, v38
    v_add_u32 v38, 33792, v38
    v_and_b32 v54, 1, v15
    v_lshlrev_b32 v54, 4, v54
    v_mul_u32_u24 v39, 6, v23
    v_and_b32 v39, -4, v39
    v_add_u32 v39, 33792, v39
    v_and_b32 v55, 1, v23
    v_lshlrev_b32 v55, 4, v55
    ds_read2_b32 v[56:57], v24 offset0:0 offset1:1
    ds_read2_b32 v[58:59], v25 offset0:0 offset1:1
    ds_read2_b32 v[60:61], v26 offset0:0 offset1:1
    ds_read2_b32 v[62:63], v27 offset0:0 offset1:1
    ds_read2_b32 v[64:65], v28 offset0:0 offset1:1
    ds_read2_b32 v[66:67], v29 offset0:0 offset1:1
    ds_read2_b32 v[68:69], v30 offset0:0 offset1:1
    ds_read2_b32 v[70:71], v31 offset0:0 offset1:1
    ds_read2_b32 v[72:73], v32 offset0:0 offset1:1
    ds_read2_b32 v[74:75], v33 offset0:0 offset1:1
    ds_read2_b32 v[76:77], v34 offset0:0 offset1:1
    ds_read2_b32 v[78:79], v35 offset0:0 offset1:1
    ds_read2_b32 v[80:81], v36 offset0:0 offset1:1
    ds_read2_b32 v[82:83], v37 offset0:0 offset1:1
    ds_read2_b32 v[84:85], v38 offset0:0 offset1:1
    ds_read2_b32 v[86:87], v39 offset0:0 offset1:1
    v_mov_b32 v103, 1
    s_waitcnt lgkmcnt(14)
    v_alignbit_b32 v56, v57, v56, v40
    v_lshrrev_b32 v57, v40, v57
    v_lshlrev_b32 v88, 16, v56
    v_and_b32 v89, 0xffff0000, v56
    v_lshlrev_b32 v90, 16, v57
    v_alignbit_b32 v58, v59, v58, v41
    v_lshrrev_b32 v59, v41, v59
    v_lshlrev_b32 v91, 16, v58
    v_and_b32 v92, 0xffff0000, v58
    v_lshlrev_b32 v93, 16, v59
    v_sub_f32 v94, v88, v91
    v_sub_f32 v95, v89, v92
    v_sub_f32 v96, v90, v93
    v_cvt_pk_bf16_f32 v98, v94, v95
    v_lshlrev_b32 v94, 16, v98
    v_and_b32 v95, 0xffff0000, v98
    v_cvt_pk_bf16_f32 v98, v96, v96
    v_lshlrev_b32 v96, 16, v98
    v_mul_f32 v99, v94, v94
    v_mul_f32 v100, v95, v95
    v_mul_f32 v101, v96, v96
    v_cvt_pk_bf16_f32 v98, v99, v100
    v_lshlrev_b32 v99, 16, v98
    v_and_b32 v100, 0xffff0000, v98
    v_cvt_pk_bf16_f32 v98, v101, v101
    v_lshlrev_b32 v101, 16, v98
    v_add_f32 v97, v99, v100
    v_add_f32 v97, v97, v101
    v_cvt_pk_bf16_f32 v98, v97, v97
    v_lshlrev_b32 v97, 16, v98
    v_add_f32 v97, 0x322bcc77, v97
    v_cvt_pk_bf16_f32 v98, v97, v97
    v_lshlrev_b32 v97, 16, v98
    v_sqrt_f32 v97, v97
    s_nop 0
    v_cvt_pk_bf16_f32 v98, v97, v97
    v_lshlrev_b32 v97, 16, v98
    v_cmp_gt_f32 vcc, 0x40a00000, v97
    s_and_saveexec_b64 s[74:75], vcc
    s_cbranch_execz L_e_na0
    v_mul_u32_u24 v104, 13401, v16
    v_lshrrev_b32 v104, 22, v104
    v_lshlrev_b32 v106, 2, v104
    ds_add_rtn_u32 v105, v106, v103 offset:0
    v_mov_b32 v106, 512
    ds_add_rtn_u32 v106, v106, v103
    v_lshl_or_b32 v108, v16, 14, v8
    s_waitcnt lgkmcnt(0)
    v_mov_b32 v109, v105
    v_lshlrev_b32 v106, 3, v106
    ds_write_b64 v106, v[108:109] offset:1024
L_e_na0:
    s_mov_b64 exec, s[74:75]
    s_waitcnt lgkmcnt(12)
    v_alignbit_b32 v60, v61, v60, v42
    v_lshrrev_b32 v61, v42, v61
    v_lshlrev_b32 v88, 16, v60
    v_and_b32 v89, 0xffff0000, v60
    v_lshlrev_b32 v90, 16, v61
    v_alignbit_b32 v62, v63, v62, v43
    v_lshrrev_b32 v63, v43, v63
    v_lshlrev_b32 v91, 16, v62
    v_and_b32 v92, 0xffff0000, v62
    v_lshlrev_b32 v93, 16, v63
    v_sub_f32 v94, v88, v91
    v_sub_f32 v95, v89, v92
    v_sub_f32 v96, v90, v93
    v_cvt_pk_bf16_f32 v98, v94, v95
    v_lshlrev_b32 v94, 16, v98
    v_and_b32 v95, 0xffff0000, v98
    v_cvt_pk_bf16_f32 v98, v96, v96
    v_lshlrev_b32 v96, 16, v98
    v_mul_f32 v99, v94, v94
    v_mul_f32 v100, v95, v95
    v_mul_f32 v101, v96, v96
    v_cvt_pk_bf16_f32 v98, v99, v100
    v_lshlrev_b32 v99, 16, v98
    v_and_b32 v100, 0xffff0000, v98
    v_cvt_pk_bf16_f32 v98, v101, v101
    v_lshlrev_b32 v101, 16, v98
    v_add_f32 v97, v99, v100
    v_add_f32 v97, v97, v101
    v_cvt_pk_bf16_f32 v98, v97, v97
    v_lshlrev_b32 v97, 16, v98
    v_add_f32 v97, 0x322bcc77, v97
    v_cvt_pk_bf16_f32 v98, v97, v97
    v_lshlrev_b32 v97, 16, v98
    v_sqrt_f32 v97, v97
    s_nop 0
    v_cvt_pk_bf16_f32 v98, v97, v97
    v_lshlrev_b32 v97, 16, v98
    v_cmp_gt_f32 vcc, 0x40a00000, v97
    s_and_saveexec_b64 s[74:75], vcc
    s_cbranch_execz L_e_na1
    v_mul_u32_u24 v104, 13401, v17
    v_lshrrev_b32 v104, 22, v104
    v_lshlrev_b32 v106, 2, v104
    ds_add_rtn_u32 v105, v106, v103 offset:0
    v_mov_b32 v106, 512
    ds_add_rtn_u32 v106, v106, v103
    v_lshl_or_b32 v108, v17, 14, v9
    s_waitcnt lgkmcnt(0)
    v_mov_b32 v109, v105
    v_lshlrev_b32 v106, 3, v106
    ds_write_b64 v106, v[108:109] offset:1024
L_e_na1:
    s_mov_b64 exec, s[74:75]
    s_waitcnt lgkmcnt(10)
    v_alignbit_b32 v64, v65, v64, v44
    v_lshrrev_b32 v65, v44, v65
    v_lshlrev_b32 v88, 16, v64
    v_and_b32 v89, 0xffff0000, v64
    v_lshlrev_b32 v90, 16, v65
    v_alignbit_b32 v66, v67, v66, v45
    v_lshrrev_b32 v67, v45, v67
    v_lshlrev_b32 v91, 16, v66
    v_and_b32 v92, 0xffff0000, v66
    v_lshlrev_b32 v93, 16, v67
    v_sub_f32 v94, v88, v91
    v_sub_f32 v95, v89, v92
    v_sub_f32 v96, v90, v93
    v_cvt_pk_bf16_f32 v98, v94, v95
    v_lshlrev_b32 v94, 16, v98
    v_and_b32 v95, 0xffff0000, v98
    v_cvt_pk_bf16_f32 v98, v96, v96
    v_lshlrev_b32 v96, 16, v98
    v_mul_f32 v99, v94, v94
    v_mul_f32 v100, v95, v95
    v_mul_f32 v101, v96, v96
    v_cvt_pk_bf16_f32 v98, v99, v100
    v_lshlrev_b32 v99, 16, v98
    v_and_b32 v100, 0xffff0000, v98
    v_cvt_pk_bf16_f32 v98, v101, v101
    v_lshlrev_b32 v101, 16, v98
    v_add_f32 v97, v99, v100
    v_add_f32 v97, v97, v101
    v_cvt_pk_bf16_f32 v98, v97, v97
    v_lshlrev_b32 v97, 16, v98
    v_add_f32 v97, 0x322bcc77, v97
    v_cvt_pk_bf16_f32 v98, v97, v97
    v_lshlrev_b32 v97, 16, v98
    v_sqrt_f32 v97, v97
    s_nop 0
    v_cvt_pk_bf16_f32 v98, v97, v97
    v_lshlrev_b32 v97, 16, v98
    v_cmp_gt_f32 vcc, 0x40a00000, v97
    s_and_saveexec_b64 s[74:75], vcc
    s_cbranch_execz L_e_na2
    v_mul_u32_u24 v104, 13401, v18
    v_lshrrev_b32 v104, 22, v104
    v_lshlrev_b32 v106, 2, v104
    ds_add_rtn_u32 v105, v106, v103 offset:0
    v_mov_b32 v106, 512
    ds_add_rtn_u32 v106, v106, v103
    v_lshl_or_b32 v108, v18, 14, v10
    s_waitcnt lgkmcnt(0)
    v_mov_b32 v109, v105
    v_lshlrev_b32 v106, 3, v106
    ds_write_b64 v106, v[108:109] offset:1024
L_e_na2:
    s_mov_b64 exec, s[74:75]
    s_waitcnt lgkmcnt(8)
    v_alignbit_b32 v68, v69, v68, v46
    v_lshrrev_b32 v69, v46, v69
    v_lshlrev_b32 v88, 16, v68
    v_and_b32 v89, 0xffff0000, v68
    v_lshlrev_b32 v90, 16, v69
    v_alignbit_b32 v70, v71, v70, v47
    v_lshrrev_b32 v71, v47, v71
    v_lshlrev_b32 v91, 16, v70
    v_and_b32 v92, 0xffff0000, v70
    v_lshlrev_b32 v93, 16, v71
    v_sub_f32 v94, v88, v91
    v_sub_f32 v95, v89, v92
    v_sub_f32 v96, v90, v93
    v_cvt_pk_bf16_f32 v98, v94, v95
    v_lshlrev_b32 v94, 16, v98
    v_and_b32 v95, 0xffff0000, v98
    v_cvt_pk_bf16_f32 v98, v96, v96
    v_lshlrev_b32 v96, 16, v98
    v_mul_f32 v99, v94, v94
    v_mul_f32 v100, v95, v95
    v_mul_f32 v101, v96, v96
    v_cvt_pk_bf16_f32 v98, v99, v100
    v_lshlrev_b32 v99, 16, v98
    v_and_b32 v100, 0xffff0000, v98
    v_cvt_pk_bf16_f32 v98, v101, v101
    v_lshlrev_b32 v101, 16, v98
    v_add_f32 v97, v99, v100
    v_add_f32 v97, v97, v101
    v_cvt_pk_bf16_f32 v98, v97, v97
    v_lshlrev_b32 v97, 16, v98
    v_add_f32 v97, 0x322bcc77, v97
    v_cvt_pk_bf16_f32 v98, v97, v97
    v_lshlrev_b32 v97, 16, v98
    v_sqrt_f32 v97, v97
    s_nop 0
    v_cvt_pk_bf16_f32 v98, v97, v97
    v_lshlrev_b32 v97, 16, v98
    v_cmp_gt_f32 vcc, 0x40a00000, v97
    s_and_saveexec_b64 s[74:75], vcc
    s_cbranch_execz L_e_na3
    v_mul_u32_u24 v104, 13401, v19
    v_lshrrev_b32 v104, 22, v104
    v_lshlrev_b32 v106, 2, v104
    ds_add_rtn_u32 v105, v106, v103 offset:0
    v_mov_b32 v106, 512
    ds_add_rtn_u32 v106, v106, v103
    v_lshl_or_b32 v108, v19, 14, v11
    s_waitcnt lgkmcnt(0)
    v_mov_b32 v109, v105
    v_lshlrev_b32 v106, 3, v106
    ds_write_b64 v106, v[108:109] offset:1024
L_e_na3:
    s_mov_b64 exec, s[74:75]
    s_waitcnt lgkmcnt(6)
    v_alignbit_b32 v72, v73, v72, v48
    v_lshrrev_b32 v73, v48, v73
    v_lshlrev_b32 v88, 16, v72
    v_and_b32 v89, 0xffff0000, v72
    v_lshlrev_b32 v90, 16, v73
    v_alignbit_b32 v74, v75, v74, v49
    v_lshrrev_b32 v75, v49, v75
    v_lshlrev_b32 v91, 16, v74
    v_and_b32 v92, 0xffff0000, v74
    v_lshlrev_b32 v93, 16, v75
    v_sub_f32 v94, v88, v91
    v_sub_f32 v95, v89, v92
    v_sub_f32 v96, v90, v93
    v_cvt_pk_bf16_f32 v98, v94, v95
    v_lshlrev_b32 v94, 16, v98
    v_and_b32 v95, 0xffff0000, v98
    v_cvt_pk_bf16_f32 v98, v96, v96
    v_lshlrev_b32 v96, 16, v98
    v_mul_f32 v99, v94, v94
    v_mul_f32 v100, v95, v95
    v_mul_f32 v101, v96, v96
    v_cvt_pk_bf16_f32 v98, v99, v100
    v_lshlrev_b32 v99, 16, v98
    v_and_b32 v100, 0xffff0000, v98
    v_cvt_pk_bf16_f32 v98, v101, v101
    v_lshlrev_b32 v101, 16, v98
    v_add_f32 v97, v99, v100
    v_add_f32 v97, v97, v101
    v_cvt_pk_bf16_f32 v98, v97, v97
    v_lshlrev_b32 v97, 16, v98
    v_add_f32 v97, 0x322bcc77, v97
    v_cvt_pk_bf16_f32 v98, v97, v97
    v_lshlrev_b32 v97, 16, v98
    v_sqrt_f32 v97, v97
    s_nop 0
    v_cvt_pk_bf16_f32 v98, v97, v97
    v_lshlrev_b32 v97, 16, v98
    v_cmp_gt_f32 vcc, 0x40a00000, v97
    s_and_saveexec_b64 s[74:75], vcc
    s_cbranch_execz L_e_na4
    v_mul_u32_u24 v104, 13401, v20
    v_lshrrev_b32 v104, 22, v104
    v_lshlrev_b32 v106, 2, v104
    ds_add_rtn_u32 v105, v106, v103 offset:0
    v_mov_b32 v106, 512
    ds_add_rtn_u32 v106, v106, v103
    v_lshl_or_b32 v108, v20, 14, v12
    s_waitcnt lgkmcnt(0)
    v_mov_b32 v109, v105
    v_lshlrev_b32 v106, 3, v106
    ds_write_b64 v106, v[108:109] offset:1024
L_e_na4:
    s_mov_b64 exec, s[74:75]
    s_waitcnt lgkmcnt(4)
    v_alignbit_b32 v76, v77, v76, v50
    v_lshrrev_b32 v77, v50, v77
    v_lshlrev_b32 v88, 16, v76
    v_and_b32 v89, 0xffff0000, v76
    v_lshlrev_b32 v90, 16, v77
    v_alignbit_b32 v78, v79, v78, v51
    v_lshrrev_b32 v79, v51, v79
    v_lshlrev_b32 v91, 16, v78
    v_and_b32 v92, 0xffff0000, v78
    v_lshlrev_b32 v93, 16, v79
    v_sub_f32 v94, v88, v91
    v_sub_f32 v95, v89, v92
    v_sub_f32 v96, v90, v93
    v_cvt_pk_bf16_f32 v98, v94, v95
    v_lshlrev_b32 v94, 16, v98
    v_and_b32 v95, 0xffff0000, v98
    v_cvt_pk_bf16_f32 v98, v96, v96
    v_lshlrev_b32 v96, 16, v98
    v_mul_f32 v99, v94, v94
    v_mul_f32 v100, v95, v95
    v_mul_f32 v101, v96, v96
    v_cvt_pk_bf16_f32 v98, v99, v100
    v_lshlrev_b32 v99, 16, v98
    v_and_b32 v100, 0xffff0000, v98
    v_cvt_pk_bf16_f32 v98, v101, v101
    v_lshlrev_b32 v101, 16, v98
    v_add_f32 v97, v99, v100
    v_add_f32 v97, v97, v101
    v_cvt_pk_bf16_f32 v98, v97, v97
    v_lshlrev_b32 v97, 16, v98
    v_add_f32 v97, 0x322bcc77, v97
    v_cvt_pk_bf16_f32 v98, v97, v97
    v_lshlrev_b32 v97, 16, v98
    v_sqrt_f32 v97, v97
    s_nop 0
    v_cvt_pk_bf16_f32 v98, v97, v97
    v_lshlrev_b32 v97, 16, v98
    v_cmp_gt_f32 vcc, 0x40a00000, v97
    s_and_saveexec_b64 s[74:75], vcc
    s_cbranch_execz L_e_na5
    v_mul_u32_u24 v104, 13401, v21
    v_lshrrev_b32 v104, 22, v104
    v_lshlrev_b32 v106, 2, v104
    ds_add_rtn_u32 v105, v106, v103 offset:0
    v_mov_b32 v106, 512
    ds_add_rtn_u32 v106, v106, v103
    v_lshl_or_b32 v108, v21, 14, v13
    s_waitcnt lgkmcnt(0)
    v_mov_b32 v109, v105
    v_lshlrev_b32 v106, 3, v106
    ds_write_b64 v106, v[108:109] offset:1024
L_e_na5:
    s_mov_b64 exec, s[74:75]
    s_waitcnt lgkmcnt(2)
    v_alignbit_b32 v80, v81, v80, v52
    v_lshrrev_b32 v81, v52, v81
    v_lshlrev_b32 v88, 16, v80
    v_and_b32 v89, 0xffff0000, v80
    v_lshlrev_b32 v90, 16, v81
    v_alignbit_b32 v82, v83, v82, v53
    v_lshrrev_b32 v83, v53, v83
    v_lshlrev_b32 v91, 16, v82
    v_and_b32 v92, 0xffff0000, v82
    v_lshlrev_b32 v93, 16, v83
    v_sub_f32 v94, v88, v91
    v_sub_f32 v95, v89, v92
    v_sub_f32 v96, v90, v93
    v_cvt_pk_bf16_f32 v98, v94, v95
    v_lshlrev_b32 v94, 16, v98
    v_and_b32 v95, 0xffff0000, v98
    v_cvt_pk_bf16_f32 v98, v96, v96
    v_lshlrev_b32 v96, 16, v98
    v_mul_f32 v99, v94, v94
    v_mul_f32 v100, v95, v95
    v_mul_f32 v101, v96, v96
    v_cvt_pk_bf16_f32 v98, v99, v100
    v_lshlrev_b32 v99, 16, v98
    v_and_b32 v100, 0xffff0000, v98
    v_cvt_pk_bf16_f32 v98, v101, v101
    v_lshlrev_b32 v101, 16, v98
    v_add_f32 v97, v99, v100
    v_add_f32 v97, v97, v101
    v_cvt_pk_bf16_f32 v98, v97, v97
    v_lshlrev_b32 v97, 16, v98
    v_add_f32 v97, 0x322bcc77, v97
    v_cvt_pk_bf16_f32 v98, v97, v97
    v_lshlrev_b32 v97, 16, v98
    v_sqrt_f32 v97, v97
    s_nop 0
    v_cvt_pk_bf16_f32 v98, v97, v97
    v_lshlrev_b32 v97, 16, v98
    v_cmp_gt_f32 vcc, 0x40a00000, v97
    s_and_saveexec_b64 s[74:75], vcc
    s_cbranch_execz L_e_na6
    v_mul_u32_u24 v104, 13401, v22
    v_lshrrev_b32 v104, 22, v104
    v_lshlrev_b32 v106, 2, v104
    ds_add_rtn_u32 v105, v106, v103 offset:0
    v_mov_b32 v106, 512
    ds_add_rtn_u32 v106, v106, v103
    v_lshl_or_b32 v108, v22, 14, v14
    s_waitcnt lgkmcnt(0)
    v_mov_b32 v109, v105
    v_lshlrev_b32 v106, 3, v106
    ds_write_b64 v106, v[108:109] offset:1024
L_e_na6:
    s_mov_b64 exec, s[74:75]
    s_waitcnt lgkmcnt(0)
    v_alignbit_b32 v84, v85, v84, v54
    v_lshrrev_b32 v85, v54, v85
    v_lshlrev_b32 v88, 16, v84
    v_and_b32 v89, 0xffff0000, v84
    v_lshlrev_b32 v90, 16, v85
    v_alignbit_b32 v86, v87, v86, v55
    v_lshrrev_b32 v87, v55, v87
    v_lshlrev_b32 v91, 16, v86
    v_and_b32 v92, 0xffff0000, v86
    v_lshlrev_b32 v93, 16, v87
    v_sub_f32 v94, v88, v91
    v_sub_f32 v95, v89, v92
    v_sub_f32 v96, v90, v93
    v_cvt_pk_bf16_f32 v98, v94, v95
    v_lshlrev_b32 v94, 16, v98
    v_and_b32 v95, 0xffff0000, v98
    v_cvt_pk_bf16_f32 v98, v96, v96
    v_lshlrev_b32 v96, 16, v98
    v_mul_f32 v99, v94, v94
    v_mul_f32 v100, v95, v95
    v_mul_f32 v101, v96, v96
    v_cvt_pk_bf16_f32 v98, v99, v100
    v_lshlrev_b32 v99, 16, v98
    v_and_b32 v100, 0xffff0000, v98
    v_cvt_pk_bf16_f32 v98, v101, v101
    v_lshlrev_b32 v101, 16, v98
    v_add_f32 v97, v99, v100
    v_add_f32 v97, v97, v101
    v_cvt_pk_bf16_f32 v98, v97, v97
    v_lshlrev_b32 v97, 16, v98
    v_add_f32 v97, 0x322bcc77, v97
    v_cvt_pk_bf16_f32 v98, v97, v97
    v_lshlrev_b32 v97, 16, v98
    v_sqrt_f32 v97, v97
    s_nop 0
    v_cvt_pk_bf16_f32 v98, v97, v97
    v_lshlrev_b32 v97, 16, v98
    v_cmp_gt_f32 vcc, 0x40a00000, v97
    s_and_saveexec_b64 s[74:75], vcc
    s_cbranch_execz L_e_na7
    v_mul_u32_u24 v104, 13401, v23
    v_lshrrev_b32 v104, 22, v104
    v_lshlrev_b32 v106, 2, v104
    ds_add_rtn_u32 v105, v106, v103 offset:0
    v_mov_b32 v106, 512
    ds_add_rtn_u32 v106, v106, v103
    v_lshl_or_b32 v108, v23, 14, v15
    s_waitcnt lgkmcnt(0)
    v_mov_b32 v109, v105
    v_lshlrev_b32 v106, 3, v106
    ds_write_b64 v106, v[108:109] offset:1024
L_e_na7:
    s_mov_b64 exec, s[74:75]
L_e_pass1_done:
    s_mov_b64 exec, s[72:73]
    s_waitcnt lgkmcnt(0)
    s_barrier
    s_cmp_eq_u32 s64, 0
    s_cbranch_scc0 L_e_noatom
    v_lshlrev_b32 v26, 2, v2
    ds_read_b32 v24, v26 offset:0
    s_waitcnt lgkmcnt(0)
    v_mov_b32 v25, v24
    buffer_atomic_add v25, v26, s[52:55], 0 offen sc0
    s_lshl_b32 s65, s2, 8
    buffer_store_dword v24, v26, s[56:59], s65 offen
L_e_noatom:
    v_mov_b32 v28, 512
    ds_read_b32 v28, v28
    s_waitcnt lgkmcnt(0)
    v_readfirstlane_b32 s76, v28
    v_mov_b32 v29, v0
    s_mov_b32 s79, 0
    s_mov_b32 s77, 0
L_e_loop:
    v_cmp_gt_u32 vcc, s76, v29
    s_and_saveexec_b64 s[72:73], vcc
    s_cbranch_execz L_e_geo_done
    v_lshlrev_b32 v32, 3, v29
    ds_read_b64 v[30:31], v32 offset:1024
    s_waitcnt lgkmcnt(0)
    v_and_b32 v33, 0x3fff, v30
    v_lshrrev_b32 v34, 14, v30
    v_mul_u32_u24 v36, 6, v33
    v_and_b32 v36, -4, v36
    v_add_u32 v36, 33792, v36
    v_and_b32 v38, 1, v33
    v_lshlrev_b32 v38, 4, v38
    v_mul_u32_u24 v37, 6, v34
    v_and_b32 v37, -4, v37
    v_add_u32 v37, 33792, v37
    v_and_b32 v39, 1, v34
    v_lshlrev_b32 v39, 4, v39
    ds_read2_b32 v[40:41], v36 offset0:0 offset1:1
    ds_read2_b32 v[42:43], v37 offset0:0 offset1:1
    v_mul_u32_u24 v104, 13401, v34
    v_lshrrev_b32 v104, 22, v104
    s_waitcnt lgkmcnt(0)
    v_alignbit_b32 v40, v41, v40, v38
    v_lshrrev_b32 v41, v38, v41
    v_lshlrev_b32 v88, 16, v40
    v_and_b32 v89, 0xffff0000, v40
    v_lshlrev_b32 v90, 16, v41
    v_alignbit_b32 v42, v43, v42, v39
    v_lshrrev_b32 v43, v39, v43
    v_lshlrev_b32 v91, 16, v42
    v_and_b32 v92, 0xffff0000, v42
    v_lshlrev_b32 v93, 16, v43
    v_sub_f32 v94, v88, v91
    v_sub_f32 v95, v89, v92
    v_sub_f32 v96, v90, v93
    v_cvt_pk_bf16_f32 v98, v94, v95
    v_lshlrev_b32 v94, 16, v98
    v_and_b32 v95, 0xffff0000, v98
    v_cvt_pk_bf16_f32 v98, v96, v96
    v_lshlrev_b32 v96, 16, v98
    v_mul_f32 v99, v94, v94
    v_mul_f32 v100, v95, v95
    v_mul_f32 v101, v96, v96
    v_cvt_pk_bf16_f32 v98, v99, v100
    v_lshlrev_b32 v99, 16, v98
    v_and_b32 v100, 0xffff0000, v98
    v_cvt_pk_bf16_f32 v98, v101, v101
    v_lshlrev_b32 v101, 16, v98
    v_add_f32 v97, v99, v100
    v_add_f32 v97, v97, v101
    v_cvt_pk_bf16_f32 v98, v97, v97
    v_lshlrev_b32 v97, 16, v98
    v_add_f32 v97, 0x322bcc77, v97
    v_cvt_pk_bf16_f32 v98, v97, v97
    v_lshlrev_b32 v97, 16, v98
    v_sqrt_f32 v97, v97
    s_nop 0
    v_cvt_pk_bf16_f32 v98, v97, v97
    v_lshlrev_b32 v97, 16, v98
    v_rcp_f32 v44, v97
    v_mul_f32 v46, s68, v97
    v_mul_f32 v47, s69, v97
    v_mul_f32 v48, s70, v97
    v_mul_f32 v49, s71, v97
    v_cvt_pk_bf16_f32 v98, v46, v47
    v_lshlrev_b32 v46, 16, v98
    v_and_b32 v47, 0xffff0000, v98
    v_cvt_pk_bf16_f32 v98, v48, v49
    v_lshlrev_b32 v48, 16, v98
    v_and_b32 v49, 0xffff0000, v98
    v_mul_f32 v46, 0.15915494, v46
    v_mul_f32 v47, 0.15915494, v47
    v_mul_f32 v48, 0.15915494, v48
    v_mul_f32 v49, 0.15915494, v49
    v_sin_f32 v46, v46
    v_sin_f32 v47, v47
    v_sin_f32 v48, v48
    v_sin_f32 v49, v49
    v_mul_f32 v45, 0x40490fdb, v97
    v_cvt_pk_bf16_f32 v98, v46, v47
    v_lshlrev_b32 v46, 16, v98
    v_and_b32 v47, 0xffff0000, v98
    v_cvt_pk_bf16_f32 v98, v48, v49
    v_lshlrev_b32 v48, 16, v98
    v_and_b32 v49, 0xffff0000, v98
    v_cvt_pk_bf16_f32 v98, v45, v45
    v_lshlrev_b32 v45, 16, v98
    v_mul_f32 v45, 0x3e4ccccd, v45
    v_cvt_pk_bf16_f32 v98, v45, v45
    v_lshlrev_b32 v45, 16, v98
    v_mul_f32 v45, 0.15915494, v45
    v_cos_f32 v45, v45
    v_mul_f32 v46, v46, v44
    v_mul_f32 v47, v47, v44
    v_mul_f32 v48, v48, v44
    v_mul_f32 v49, v49, v44
    v_cvt_pk_bf16_f32 v98, v45, v45
    v_lshlrev_b32 v45, 16, v98
    v_cvt_pk_bf16_f32 v98, v46, v47
    v_lshlrev_b32 v46, 16, v98
    v_and_b32 v47, 0xffff0000, v98
    v_cvt_pk_bf16_f32 v98, v48, v49
    v_lshlrev_b32 v48, 16, v98
    v_and_b32 v49, 0xffff0000, v98
    v_add_f32 v45, 1.0, v45
    v_cvt_pk_bf16_f32 v98, v45, v45
    v_lshlrev_b32 v45, 16, v98
    v_mul_f32 v45, 0.5, v45
    v_mul_f32 v94, v94, v44
    v_mul_f32 v95, v95, v44
    v_mul_f32 v96, v96, v44
    v_mul_f32 v46, v46, v45
    v_mul_f32 v47, v47, v45
    v_mul_f32 v48, v48, v45
    v_mul_f32 v49, v49, v45
    v_cvt_pk_bf16_f32 v53, v46, v47
    v_cvt_pk_bf16_f32 v54, v48, v49
    v_cvt_pk_bf16_f32 v55, v94, v95
    v_cvt_pk_bf16_f32 v56, v96, v96
    v_mul_u32_u24 v57, 313, v104
    v_sub_u32 v57, v34, v57
    v_lshl_or_b32 v52, v57, 14, v33
L_e_geo_done:
    s_mov_b64 exec, s[72:73]
    s_cmp_eq_u32 s77, 0
    s_cbranch_scc0 L_e_store
    s_mov_b32 s77, 1
    s_cmp_eq_u32 s64, 0
    s_cbranch_scc0 L_e_nobase
    s_waitcnt vmcnt(0)
    ds_write_b32 v26, v25 offset:256
L_e_nobase:
    s_waitcnt lgkmcnt(0)
    s_barrier
    s_waitcnt lgkmcnt(0)
L_e_store:
    v_cmp_gt_u32 vcc, s76, v29
    s_and_saveexec_b64 s[72:73], vcc
    s_cbranch_execz L_e_st_done
    v_lshlrev_b32 v58, 2, v104
    ds_read_b32 v58, v58 offset:256
    s_waitcnt lgkmcnt(0)
    v_add_u32 v58, v58, v31
    v_lshl_add_u32 v59, v104, 10, v58
    v_mul_u32_u24 v59, 20, v59
    s_mov_b32 s78, 3200000
    v_mul_lo_u32 v60, v104, s78
    v_mul_u32_u24 v61, 20, v58
    v_add_u32 v60, v60, v61
    v_add_u32 v60, 655360, v60
    v_cmp_gt_u32 vcc, 1024, v58
    s_nop 1
    v_cndmask_b32 v59, v60, v59, vcc
    buffer_store_dwordx4 v[52:55], v59, s[60:63], 0 offen
    buffer_store_dword v56, v59, s[60:63], 0 offen offset:16
L_e_st_done:
    s_mov_b64 exec, s[72:73]
    v_add_u32 v29, 768, v29
    s_add_u32 s79, s79, 768
    s_cmp_lt_u32 s79, s76
    s_cbranch_scc1 L_e_loop
    s_endpgm
L_k1_exit:
    s_endpgm
.globl painn_k2_kernel
.p2align 8
.type painn_k2_kernel,@function
painn_k2_kernel:
    s_cmp_ge_u32 s2, 256
    s_cbranch_scc1 L_k2_exit
    s_load_dwordx16 s[16:31], s[0:1], 0
    s_load_dwordx4 s[32:35], s[0:1], 64
    s_load_dwordx2 s[36:37], s[0:1], 80
    v_lshrrev_b32 v1, 6, v0
    v_and_b32 v2, 63, v0
    s_and_b32 s65, s2, 7
    s_and_b32 s38, s65, 1
    s_lshr_b32 s65, s65, 1
    s_lshr_b32 s66, s2, 3
    s_mul_i32 s67, s66, 313
    s_sub_u32 s68, 10000, s67
    s_min_u32 s68, s68, 313
    v_lshlrev_b32 v5, 2, v0
    v_mov_b32 v6, 0
    v_cmp_gt_u32 vcc, 320, v0
    s_and_saveexec_b64 s[70:71], vcc
    ds_write_b32 v5, v6 offset:0
    s_mov_b64 exec, s[70:71]
    v_cmp_gt_u32 vcc, 32, v0
    s_and_saveexec_b64 s[70:71], vcc
    ds_write_b32 v5, v6 offset:3840
    s_mov_b64 exec, s[70:71]
    s_waitcnt lgkmcnt(0)
    v_readfirstlane_b32 s64, v1
    s_add_u32 s52, s36, 33554432
    s_addc_u32 s53, s37, 0
    s_mov_b32 s54, 103055360
    s_mov_b32 s55, 0x00020000
    s_add_u32 s56, s36, 31000064
    s_addc_u32 s57, s37, 0
    s_mov_b32 s58, 10240
    s_mov_b32 s59, 0x00020000
    v_lshlrev_b32 v4, 8, v2
    s_lshl_b32 s69, s66, 2
    buffer_load_dword v13, v4, s[56:59], s69 offen
    s_cmp_ge_u32 s64, 8
    s_cbranch_scc1 L_k2_norec
    s_lshl_b32 s69, s66, 10
    v_add_u32 v3, s69, v0
    v_mul_u32_u24 v3, 20, v3
    buffer_load_dwordx4 v[8:11], v3, s[52:55], 0 offen
    buffer_load_dword v12, v3, s[52:55], 0 offen offset:16
    v_add_u32 v3, 10240, v3
    buffer_load_dwordx4 v[16:19], v3, s[52:55], 0 offen
    buffer_load_dword v20, v3, s[52:55], 0 offen offset:16
L_k2_norec:
    s_mul_i32 s69, s65, 3870720
    s_add_u32 s40, s36, s69
    s_addc_u32 s41, s37, 0
    s_mov_b32 s42, 3870720
    s_mov_b32 s43, 0x00020000
    s_mov_b32 s44, s16
    s_mov_b32 s45, s17
    s_mov_b32 s46, 20480000
    s_mov_b32 s47, 0x00020000
    s_mov_b32 s48, s32
    s_mov_b32 s49, s33
    s_mov_b32 s50, 20480000
    s_mov_b32 s51, 0x00020000
    s_mov_b32 s60, s30
    s_mov_b32 s61, s31
    s_mov_b32 s62, 6144
    s_mov_b32 s63, 0x00020000
    s_barrier
    s_cmp_ge_u32 s64, 8
    s_cbranch_scc0 L_k2_sorter
    s_cmp_eq_u32 s64, 8
    s_cbranch_scc0 L_k2_now
    v_and_b32 v7, 15, v2
    v_lshlrev_b32 v7, 2, v7
    v_lshrrev_b32 v6, 4, v2
    v_add_u32 v7, v7, v6
    s_lshl_b32 s69, s65, 6
    v_add_u32 v7, s69, v7
    v_lshlrev_b32 v7, 1, v7
    s_movk_i32 s69, 3072
    buffer_load_ushort v64, v7, s[60:63], 0 offen offset:0
    buffer_load_ushort v65, v7, s[60:63], 0 offen offset:1536
    buffer_load_ushort v66, v7, s[60:63], s69 offen offset:0
    buffer_load_ushort v67, v7, s[60:63], s69 offen offset:1536
    buffer_load_ushort v68, v7, s[60:63], 0 offen offset:512
    buffer_load_ushort v69, v7, s[60:63], 0 offen offset:2048
    buffer_load_ushort v70, v7, s[60:63], s69 offen offset:512
    buffer_load_ushort v71, v7, s[60:63], s69 offen offset:2048
    buffer_load_ushort v72, v7, s[60:63], 0 offen offset:1024
    buffer_load_ushort v73, v7, s[60:63], 0 offen offset:2560
    buffer_load_ushort v74, v7, s[60:63], s69 offen offset:1024
    buffer_load_ushort v75, v7, s[60:63], s69 offen offset:2560
    s_waitcnt vmcnt(0)
    v_lshl_or_b32 v96, v65, 16, v64
    v_lshl_or_b32 v97, v67, 16, v66
    v_lshl_or_b32 v98, v69, 16, v68
    v_lshl_or_b32 v99, v71, 16, v70
    v_lshl_or_b32 v100, v73, 16, v72
    v_lshl_or_b32 v101, v75, 16, v74
    v_mul_u32_u24 v7, 24, v2
    ds_write_b64 v7, v[96:97] offset:4096
    ds_write_b64 v7, v[98:99] offset:4104
    ds_write_b64 v7, v[100:101] offset:4112
    s_mov_b64 exec, 1
    v_mov_b32 v42, 1048576
    v_mov_b32 v40, 0
    v_mov_b32 v41, 0
    v_mov_b32 v43, 0
    v_mov_b32 v44, 0
    v_mov_b32 v45, 0
    v_mov_b32 v7, 38400
    ds_write_b128 v7, v[40:43]
    ds_write_b64 v7, v[44:45] offset:16
    s_mov_b64 exec, -1
    s_waitcnt lgkmcnt(0)
    s_mov_b64 exec, 1
    v_mov_b32 v7, 3920
    v_mov_b32 v1, 1
    ds_add_u32 v7, v1
    s_mov_b64 exec, -1
L_k2_now:
    v_lshrrev_b32 v6, 4, v2
    v_add_u32 v6, s67, v6
    v_lshlrev_b32 v6, 11, v6
    v_bfe_u32 v7, v2, 3, 1
    v_lshl_add_u32 v6, v7, 9, v6
    v_and_b32 v7, 7, v2
    v_lshl_add_u32 v6, v7, 4, v6
    s_lshl_b32 s70, s38, 10
    s_lshl_b32 s71, s65, 7
    s_add_u32 s70, s70, s71
    v_add_u32 v6, s70, v6
    s_sub_u32 s69, s64, 8
L_k2_dmaloop:
    s_lshl_b32 s71, s69, 10
    s_add_u32 s71, s71, 38912
    s_mov_b32 m0, s71
    s_lshl_b32 s71, s69, 13
    buffer_load_dwordx4 v6, s[44:47], s71 offen  lds
    s_add_u32 s69, s69, 8
    s_cmp_lt_u32 s69, 79
    s_cbranch_scc1 L_k2_dmaloop
L_k2_dmaskip:
    s_waitcnt vmcnt(0)
    v_mov_b32 v14, v13
    s_nop 1
    v_add_u32_dpp v14, v14, v14 row_shr:1 row_mask:0xf bank_mask:0xf bound_ctrl:0
    s_nop 1
    v_add_u32_dpp v14, v14, v14 row_shr:2 row_mask:0xf bank_mask:0xf bound_ctrl:0
    s_nop 1
    v_add_u32_dpp v14, v14, v14 row_shr:4 row_mask:0xf bank_mask:0xf bound_ctrl:0
    s_nop 1
    v_add_u32_dpp v14, v14, v14 row_shr:8 row_mask:0xf bank_mask:0xf bound_ctrl:0
    s_nop 1
    v_readlane_b32 s72, v14, 15
    v_readlane_b32 s73, v14, 31
    v_readlane_b32 s74, v14, 47
    s_add_u32 s72, s72, s73
    s_add_u32 s72, s72, s74
    s_waitcnt lgkmcnt(0)
    s_mov_b64 exec, 1
    v_mov_b32 v7, 3924
    v_mov_b32 v1, 1
    ds_add_u32 v7, v1
    s_mov_b64 exec, -1
    v_mov_b32 v7, 3920
L_k2_sp_rdy:
    ds_read_b32 v1, v7
    s_waitcnt lgkmcnt(0)
    v_readfirstlane_b32 s69, v1
    s_cmp_ge_u32 s69, 9
    s_cbranch_scc0 L_k2_sp_rdy
    s_waitcnt lgkmcnt(0)
    s_cmp_gt_u32 s72, 1024
    s_cbranch_scc1 L_k2_slow
    s_branch L_k2_main
L_k2_sorter:
    s_waitcnt vmcnt(0)
    v_mov_b32 v14, v13
    s_nop 1
    v_add_u32_dpp v14, v14, v14 row_shr:1 row_mask:0xf bank_mask:0xf bound_ctrl:0
    s_nop 1
    v_add_u32_dpp v14, v14, v14 row_shr:2 row_mask:0xf bank_mask:0xf bound_ctrl:0
    s_nop 1
    v_add_u32_dpp v14, v14, v14 row_shr:4 row_mask:0xf bank_mask:0xf bound_ctrl:0
    s_nop 1
    v_add_u32_dpp v14, v14, v14 row_shr:8 row_mask:0xf bank_mask:0xf bound_ctrl:0
    s_nop 1
    v_readlane_b32 s72, v14, 15
    v_readlane_b32 s73, v14, 31
    v_readlane_b32 s74, v14, 47
    s_add_u32 s72, s72, s73
    s_add_u32 s72, s72, s74
    s_cmp_gt_u32 s72, 1024
    s_cbranch_scc0 L_k2_sort
    s_waitcnt lgkmcnt(0)
    s_mov_b64 exec, 1
    v_mov_b32 v7, 3920
    v_mov_b32 v1, 1
    ds_add_u32 v7, v1
    s_mov_b64 exec, -1
    v_mov_b32 v7, 3920
L_k2_sp_rdy2:
    ds_read_b32 v1, v7
    s_waitcnt lgkmcnt(0)
    v_readfirstlane_b32 s69, v1
    s_cmp_ge_u32 s69, 9
    s_cbranch_scc0 L_k2_sp_rdy2
    s_branch L_k2_slow
L_k2_sort:
    v_lshrrev_b32 v14, 14, v8
    v_lshrrev_b32 v15, 14, v16
    v_lshlrev_b32 v30, 2, v14
    v_lshlrev_b32 v31, 2, v15
    v_mov_b32 v21, 1
    v_mov_b32 v22, 1
    v_add_u32 v23, 512, v0
    v_cmp_gt_u32 s[76:77], s72, v0
    v_cmp_gt_u32 s[78:79], s72, v23
    s_mov_b64 exec, s[76:77]
    ds_add_rtn_u32 v21, v30, v21 offset:0
    s_mov_b64 exec, s[78:79]
    ds_add_rtn_u32 v22, v31, v22 offset:0
    s_mov_b64 exec, -1
    v_and_b32 v34, 0x3fff, v8
    v_mov_b32 v32, v9
    v_mov_b32 v33, v10
    v_lshlrev_b32 v35, 16, v11
    v_and_b32 v36, 0xffff0000, v11
    v_lshlrev_b32 v37, 16, v12
    v_and_b32 v42, 0x3fff, v16
    v_mov_b32 v40, v17
    v_mov_b32 v41, v18
    v_lshlrev_b32 v43, 16, v19
    v_and_b32 v44, 0xffff0000, v19
    v_lshlrev_b32 v45, 16, v20
    s_waitcnt lgkmcnt(0)
    s_mov_b64 exec, 1
    v_mov_b32 v7, 3912
    v_mov_b32 v1, 1
    ds_add_u32 v7, v1
    s_mov_b64 exec, -1
    v_mov_b32 v7, 3912
L_k2_sp_c2:
    ds_read_b32 v1, v7
    s_waitcnt lgkmcnt(0)
    v_readfirstlane_b32 s69, v1
    s_cmp_ge_u32 s69, 8
    s_cbranch_scc0 L_k2_sp_c2
    s_waitcnt lgkmcnt(0)
    s_cmp_lt_u32 s64, 5
    s_cbranch_scc0 L_k2_nonode
    ds_read_b32 v26, v5 offset:0
    v_cmp_gt_u32 s[80:81], s68, v0
    s_waitcnt lgkmcnt(0)
    v_cndmask_b32 v26, 0, v26, s[80:81]
    v_mov_b32 v27, v26
    s_nop 1
    v_add_u32_dpp v27, v27, v27 row_shr:1 row_mask:0xf bank_mask:0xf bound_ctrl:0
    s_nop 1
    v_add_u32_dpp v27, v27, v27 row_shr:2 row_mask:0xf bank_mask:0xf bound_ctrl:0
    s_nop 1
    v_add_u32_dpp v27, v27, v27 row_shr:4 row_mask:0xf bank_mask:0xf bound_ctrl:0
    s_nop 1
    v_add_u32_dpp v27, v27, v27 row_shr:8 row_mask:0xf bank_mask:0xf bound_ctrl:0
    s_nop 1
    v_add_u32_dpp v27, v27, v27 row_bcast:15 row_mask:0xa bank_mask:0xf
    s_nop 1
    v_add_u32_dpp v27, v27, v27 row_bcast:31 row_mask:0xc bank_mask:0xf
    s_nop 1
    v_readlane_b32 s82, v27, 63
    s_mov_b64 exec, 1
    v_mov_b32 v28, 3908
    v_mov_b32 v29, s82
    ds_add_rtn_u32 v29, v28, v29
    s_mov_b64 exec, -1
    v_min_u32 v48, 15, v26
    v_sub_u32 v48, 15, v48
    v_lshlrev_b32 v49, 2, v48
    v_mov_b32 v50, 1
    s_mov_b64 exec, s[80:81]
    ds_add_rtn_u32 v50, v49, v50 offset:3840
    s_mov_b64 exec, -1
    s_waitcnt lgkmcnt(0)
    v_readfirstlane_b32 s82, v29
    v_sub_u32 v27, v27, v26
    v_add_u32 v27, s82, v27
    s_mov_b64 exec, s[80:81]
    ds_write_b32 v5, v27 offset:1280
    s_mov_b64 exec, -1
L_k2_nonode:
    s_waitcnt lgkmcnt(0)
    s_mov_b64 exec, 1
    v_mov_b32 v7, 3916
    v_mov_b32 v1, 1
    ds_add_u32 v7, v1
    s_mov_b64 exec, -1
    v_mov_b32 v7, 3916
L_k2_sp_c3:
    ds_read_b32 v1, v7
    s_waitcnt lgkmcnt(0)
    v_readfirstlane_b32 s69, v1
    s_cmp_ge_u32 s69, 8
    s_cbranch_scc0 L_k2_sp_c3
    s_cmp_lt_u32 s64, 5
    s_cbranch_scc0 L_k2_noord
    v_lshlrev_b32 v51, 2, v2
    ds_read_b32 v51, v51 offset:3840
    s_waitcnt lgkmcnt(0)
    v_mov_b32 v52, v51
    s_nop 1
    v_add_u32_dpp v52, v52, v52 row_shr:1 row_mask:0xf bank_mask:0xf bound_ctrl:0
    s_nop 1
    v_add_u32_dpp v52, v52, v52 row_shr:2 row_mask:0xf bank_mask:0xf bound_ctrl:0
    s_nop 1
    v_add_u32_dpp v52, v52, v52 row_shr:4 row_mask:0xf bank_mask:0xf bound_ctrl:0
    s_nop 1
    v_add_u32_dpp v52, v52, v52 row_shr:8 row_mask:0xf bank_mask:0xf bound_ctrl:0
    s_nop 1
    v_sub_u32 v52, v52, v51
    ds_bpermute_b32 v52, v49, v52
    s_waitcnt lgkmcnt(0)
    v_add_u32 v52, v52, v50
    v_lshlrev_b32 v52, 2, v52
    s_mov_b64 exec, s[80:81]
    ds_write_b32 v52, v0 offset:2560
    s_mov_b64 exec, -1
L_k2_noord:
    ds_read_b32 v53, v30 offset:1280
    ds_read_b32 v54, v31 offset:1280
    s_waitcnt lgkmcnt(0)
    v_add_u32 v53, v53, v21
    v_add_u32 v54, v54, v22
    v_lshlrev_b32 v53, 5, v53
    v_lshlrev_b32 v54, 5, v54
    s_mov_b64 exec, s[76:77]
    ds_write_b128 v53, v[32:35] offset:5632
    ds_write_b64 v53, v[36:37] offset:5648
    s_mov_b64 exec, s[78:79]
    ds_write_b128 v54, v[40:43] offset:5632
    ds_write_b64 v54, v[44:45] offset:5648
    s_mov_b64 exec, -1
    s_waitcnt lgkmcnt(0)
    s_mov_b64 exec, 1
    v_mov_b32 v7, 3920
    v_mov_b32 v1, 1
    ds_add_u32 v7, v1
    s_mov_b64 exec, -1
    v_mov_b32 v7, 3920
L_k2_sp_rdy3:
    ds_read_b32 v1, v7
    s_waitcnt lgkmcnt(0)
    v_readfirstlane_b32 s69, v1
    s_cmp_ge_u32 s69, 9
    s_cbranch_scc0 L_k2_sp_rdy3
    s_waitcnt lgkmcnt(0)
L_k2_main:
    v_mul_u32_u24 v7, 24, v2
    ds_read_b64 v[96:97], v7 offset:4096
    ds_read_b64 v[98:99], v7 offset:4104
    ds_read_b64 v[100:101], v7 offset:4112
    v_lshrrev_b32 v106, 4, v2
    v_and_b32 v109, 3, v2
    v_cmp_eq_u32 vcc, v106, v109
    s_nop 1
    v_cndmask_b32 v106, 0, -1, vcc
    v_mov_b32 v109, 38400
    v_and_b32 v3, 15, v2
    v_lshlrev_b32 v82, 3, v3
    v_lshlrev_b32 v3, 4, v3
    s_cmp_eq_u32 s38, 0
    s_cselect_b32 s92, s40, s44
    s_cselect_b32 s93, s41, s45
    s_cselect_b32 s94, s42, s46
    s_cselect_b32 s95, s43, s47
    s_movk_i32 s39, 2048
    s_cselect_b32 s39, 384, s39
    s_lshl_b32 s77, s65, 7
    s_add_u32 s78, s77, 1024
    s_cmp_eq_u32 s38, 0
    s_cselect_b32 s78, 256, s78
    s_lshl_b32 s79, s38, 10
    s_add_u32 s79, s79, s77
    s_add_u32 s79, s79, 512
    v_add_u32 v83, s78, v82
    v_add_u32 v84, s79, v82
    s_mov_b32 s75, 0
L_k2_next:
    s_mov_b64 exec, 1
    v_mov_b32 v78, 3904
    v_mov_b32 v120, 1
    ds_add_rtn_u32 v78, v78, v120
    s_waitcnt lgkmcnt(0)
    v_readfirstlane_b32 s80, v78
    s_mov_b64 exec, -1
    s_lshl_b32 s80, s80, 2
    s_cmp_ge_u32 s80, s68
    s_cbranch_scc1 L_k2_exit
    v_lshrrev_b32 v78, 4, v2
    v_add_u32 v78, s80, v78
    v_cmp_gt_u32 s[82:83], s68, v78
    v_lshlrev_b32 v79, 2, v78
    ds_read_b32 v79, v79 offset:2560
    s_waitcnt lgkmcnt(0)
    v_cndmask_b32 v79, 0, v79, s[82:83]
    v_lshlrev_b32 v78, 2, v79
    ds_read_b32 v5, v78 offset:0
    ds_read_b32 v4, v78 offset:1280
    v_add_u32 v6, s67, v79
    v_lshlrev_b32 v6, 11, v6
    v_add_u32 v6, v6, v82
    s_lshl_b32 s84, s38, 10
    s_add_u32 s84, s84, s77
    v_add_u32 v6, s84, v6
    v_mov_b32 v78, 2130706432
    v_cndmask_b32 v6, v78, v6, s[82:83]
    v_lshlrev_b32 v7, 8, v79
    v_add_u32 v7, v7, v82
    v_add_u32 v7, 38912, v7
    s_waitcnt lgkmcnt(0)
    v_cndmask_b32 v5, 0, v5, s[82:83]
    v_lshlrev_b32 v4, 5, v4
    v_add_u32 v4, 5632, v4
    v_bfe_u32 v78, v2, 2, 2
    v_lshlrev_b32 v78, 6, v78
    ds_bpermute_b32 v107, v78, v4
    ds_bpermute_b32 v108, v78, v5
    s_waitcnt lgkmcnt(0)
    v_readlane_b32 s85, v5, 0
    v_readlane_b32 s86, v5, 16
    s_max_u32 s85, s85, s86
    v_readlane_b32 s86, v5, 32
    s_max_u32 s85, s85, s86
    v_readlane_b32 s86, v5, 48
    s_max_u32 s85, s85, s86
    v_mov_b32 v8, 0
    v_mov_b32 v9, 0
    v_mov_b32 v10, 0
    v_mov_b32 v11, 0
    v_mov_b32 v12, 0
    v_mov_b32 v13, 0
    v_mov_b32 v14, 0
    v_mov_b32 v15, 0
    s_cmp_eq_u32 s85, 0
    s_cbranch_scc1 L_k2_fin
    s_mov_b32 s81, 0
    s_lshl_b32 s87, s81, 5
    v_add_u32 v81, s87, v4
    v_cmp_lt_u32 vcc, s81, v5
    v_add_u32 v78, s87, v107
    v_cmp_lt_u32 s[90:91], s81, v108
    v_cndmask_b32 v81, v109, v81, vcc
    ds_read_b64 v[42:43], v81 offset:8
    ds_read_b64 v[44:45], v81 offset:16
    v_cndmask_b32 v78, v109, v78, s[90:91]
    ds_read_b64 v[40:41], v78
    s_waitcnt lgkmcnt(0)
    v_mul_u32_u24 v81, 384, v42
    v_add_u32 v81, v81, v3
    buffer_load_dwordx4 v[16:19], v81, s[40:43], 0 offen
    v_mad_u32_u24 v81, v42, s39, v83
    buffer_load_dwordx2 v[20:21], v81, s[92:95], 0 offen
    v_lshl_add_u32 v81, v42, 11, v84
    buffer_load_dwordx2 v[22:23], v81, s[44:47], 0 offen
    s_cmp_gt_u32 s85, 1
    s_cbranch_scc0 L_k2_primed
    s_mov_b32 s81, 1
    s_lshl_b32 s87, s81, 5
    v_add_u32 v81, s87, v4
    v_cmp_lt_u32 vcc, s81, v5
    v_add_u32 v78, s87, v107
    v_cmp_lt_u32 s[90:91], s81, v108
    v_cndmask_b32 v81, v109, v81, vcc
    ds_read_b64 v[50:51], v81 offset:8
    ds_read_b64 v[52:53], v81 offset:16
    v_cndmask_b32 v78, v109, v78, s[90:91]
    ds_read_b64 v[48:49], v78
    s_waitcnt lgkmcnt(0)
    v_mul_u32_u24 v81, 384, v50
    v_add_u32 v81, v81, v3
    buffer_load_dwordx4 v[24:27], v81, s[40:43], 0 offen
    v_mad_u32_u24 v81, v50, s39, v83
    buffer_load_dwordx2 v[28:29], v81, s[92:95], 0 offen
    v_lshl_add_u32 v81, v50, 11, v84
    buffer_load_dwordx2 v[30:31], v81, s[44:47], 0 offen
    s_cmp_gt_u32 s85, 2
    s_cbranch_scc0 L_k2_primed
    s_mov_b32 s81, 2
    s_lshl_b32 s87, s81, 5
    v_add_u32 v81, s87, v4
    v_cmp_lt_u32 vcc, s81, v5
    v_add_u32 v78, s87, v107
    v_cmp_lt_u32 s[90:91], s81, v108
    v_cndmask_b32 v81, v109, v81, vcc
    ds_read_b64 v[58:59], v81 offset:8
    ds_read_b64 v[60:61], v81 offset:16
    v_cndmask_b32 v78, v109, v78, s[90:91]
    ds_read_b64 v[56:57], v78
    s_waitcnt lgkmcnt(0)
    v_mul_u32_u24 v81, 384, v58
    v_add_u32 v81, v81, v3
    buffer_load_dwordx4 v[32:35], v81, s[40:43], 0 offen
    v_mad_u32_u24 v81, v58, s39, v83
    buffer_load_dwordx2 v[36:37], v81, s[92:95], 0 offen
    v_lshl_add_u32 v81, v58, 11, v84
    buffer_load_dwordx2 v[38:39], v81, s[44:47], 0 offen
L_k2_primed:
    s_mov_b32 s89, 0
    s_cmp_eq_u32 s38, 0
    s_cbranch_scc0 L_k2_loopB
L_k2_loopA:
    s_sub_u32 s81, s85, s89
    s_cmp_gt_u32 s81, 2
    s_cbranch_scc1 L_k2_w2_A0
    s_cmp_gt_u32 s81, 1
    s_cbranch_scc1 L_k2_w1_A0
    s_waitcnt vmcnt(0)
    s_branch L_k2_wd_A0
L_k2_w2_A0:
    s_waitcnt vmcnt(6)
    s_branch L_k2_wd_A0
L_k2_w1_A0:
    s_waitcnt vmcnt(3)
L_k2_wd_A0:
    v_and_b32 v104, v40, v106
    v_and_b32 v105, v41, v106
    v_lshlrev_b32 v120, 16, v16
    v_and_b32 v121, 0xffff0000, v16
    v_mfma_f32_16x16x16_bf16 v[68:71], v[104:105], v[98:99], 0
    v_mfma_f32_16x16x16_bf16 v[72:75], v[104:105], v[100:101], 0
    v_mfma_f32_16x16x16_bf16 v[64:67], v[104:105], v[96:97], 0
    v_lshlrev_b32 v122, 16, v17
    v_and_b32 v123, 0xffff0000, v17
    v_lshlrev_b32 v124, 16, v18
    v_and_b32 v125, 0xffff0000, v18
    v_lshlrev_b32 v126, 16, v19
    v_and_b32 v127, 0xffff0000, v19
    v_lshlrev_b32 v112, 16, v20
    v_and_b32 v113, 0xffff0000, v20
    v_lshlrev_b32 v114, 16, v21
    v_and_b32 v115, 0xffff0000, v21
    v_lshlrev_b32 v116, 16, v22
    v_and_b32 v117, 0xffff0000, v22
    v_lshlrev_b32 v118, 16, v23
    v_and_b32 v119, 0xffff0000, v23
    v_mul_f32 v68, v120, v68
    v_mul_f32 v69, v121, v69
    v_mul_f32 v70, v122, v70
    v_mul_f32 v71, v123, v71
    v_mul_f32 v72, v124, v72
    v_mul_f32 v73, v125, v73
    v_mul_f32 v74, v126, v74
    v_mul_f32 v75, v127, v75
    v_fmac_f32 v8, v112, v64
    v_fmac_f32 v9, v113, v65
    v_fmac_f32 v10, v114, v66
    v_fmac_f32 v11, v115, v67
    v_fmac_f32 v12, v116, v68
    v_fmac_f32 v12, v43, v72
    v_fmac_f32 v13, v117, v69
    v_fmac_f32 v13, v43, v73
    v_fmac_f32 v14, v118, v70
    v_fmac_f32 v14, v43, v74
    v_fmac_f32 v15, v119, v71
    v_fmac_f32 v15, v43, v75
    s_add_u32 s81, s89, 3
    s_cmp_lt_u32 s81, s85
    s_cbranch_scc0 L_k2_ni_A0
    s_lshl_b32 s87, s81, 5
    v_add_u32 v81, s87, v4
    v_cmp_lt_u32 vcc, s81, v5
    v_add_u32 v78, s87, v107
    v_cmp_lt_u32 s[90:91], s81, v108
    v_cndmask_b32 v81, v109, v81, vcc
    ds_read_b64 v[42:43], v81 offset:8
    ds_read_b64 v[44:45], v81 offset:16
    v_cndmask_b32 v78, v109, v78, s[90:91]
    ds_read_b64 v[40:41], v78
    s_waitcnt lgkmcnt(0)
    v_mul_u32_u24 v81, 384, v42
    v_add_u32 v81, v81, v3
    buffer_load_dwordx4 v[16:19], v81, s[40:43], 0 offen
    v_mad_u32_u24 v81, v42, s39, v83
    buffer_load_dwordx2 v[20:21], v81, s[92:95], 0 offen
    v_lshl_add_u32 v81, v42, 11, v84
    buffer_load_dwordx2 v[22:23], v81, s[44:47], 0 offen
L_k2_ni_A0:
    s_add_u32 s89, s89, 1
    s_cmp_lt_u32 s89, s85
    s_cbranch_scc0 L_k2_fin
    s_sub_u32 s81, s85, s89
    s_cmp_gt_u32 s81, 2
    s_cbranch_scc1 L_k2_w2_A1
    s_cmp_gt_u32 s81, 1
    s_cbranch_scc1 L_k2_w1_A1
    s_waitcnt vmcnt(0)
    s_branch L_k2_wd_A1
L_k2_w2_A1:
    s_waitcnt vmcnt(6)
    s_branch L_k2_wd_A1
L_k2_w1_A1:
    s_waitcnt vmcnt(3)
L_k2_wd_A1:
    v_and_b32 v104, v48, v106
    v_and_b32 v105, v49, v106
    v_lshlrev_b32 v120, 16, v24
    v_and_b32 v121, 0xffff0000, v24
    v_mfma_f32_16x16x16_bf16 v[68:71], v[104:105], v[98:99], 0
    v_mfma_f32_16x16x16_bf16 v[72:75], v[104:105], v[100:101], 0
    v_mfma_f32_16x16x16_bf16 v[64:67], v[104:105], v[96:97], 0
    v_lshlrev_b32 v122, 16, v25
    v_and_b32 v123, 0xffff0000, v25
    v_lshlrev_b32 v124, 16, v26
    v_and_b32 v125, 0xffff0000, v26
    v_lshlrev_b32 v126, 16, v27
    v_and_b32 v127, 0xffff0000, v27
    v_lshlrev_b32 v112, 16, v28
    v_and_b32 v113, 0xffff0000, v28
    v_lshlrev_b32 v114, 16, v29
    v_and_b32 v115, 0xffff0000, v29
    v_lshlrev_b32 v116, 16, v30
    v_and_b32 v117, 0xffff0000, v30
    v_lshlrev_b32 v118, 16, v31
    v_and_b32 v119, 0xffff0000, v31
    v_mul_f32 v68, v120, v68
    v_mul_f32 v69, v121, v69
    v_mul_f32 v70, v122, v70
    v_mul_f32 v71, v123, v71
    v_mul_f32 v72, v124, v72
    v_mul_f32 v73, v125, v73
    v_mul_f32 v74, v126, v74
    v_mul_f32 v75, v127, v75
    v_fmac_f32 v8, v112, v64
    v_fmac_f32 v9, v113, v65
    v_fmac_f32 v10, v114, v66
    v_fmac_f32 v11, v115, v67
    v_fmac_f32 v12, v116, v68
    v_fmac_f32 v12, v51, v72
    v_fmac_f32 v13, v117, v69
    v_fmac_f32 v13, v51, v73
    v_fmac_f32 v14, v118, v70
    v_fmac_f32 v14, v51, v74
    v_fmac_f32 v15, v119, v71
    v_fmac_f32 v15, v51, v75
    s_add_u32 s81, s89, 3
    s_cmp_lt_u32 s81, s85
    s_cbranch_scc0 L_k2_ni_A1
    s_lshl_b32 s87, s81, 5
    v_add_u32 v81, s87, v4
    v_cmp_lt_u32 vcc, s81, v5
    v_add_u32 v78, s87, v107
    v_cmp_lt_u32 s[90:91], s81, v108
    v_cndmask_b32 v81, v109, v81, vcc
    ds_read_b64 v[50:51], v81 offset:8
    ds_read_b64 v[52:53], v81 offset:16
    v_cndmask_b32 v78, v109, v78, s[90:91]
    ds_read_b64 v[48:49], v78
    s_waitcnt lgkmcnt(0)
    v_mul_u32_u24 v81, 384, v50
    v_add_u32 v81, v81, v3
    buffer_load_dwordx4 v[24:27], v81, s[40:43], 0 offen
    v_mad_u32_u24 v81, v50, s39, v83
    buffer_load_dwordx2 v[28:29], v81, s[92:95], 0 offen
    v_lshl_add_u32 v81, v50, 11, v84
    buffer_load_dwordx2 v[30:31], v81, s[44:47], 0 offen
L_k2_ni_A1:
    s_add_u32 s89, s89, 1
    s_cmp_lt_u32 s89, s85
    s_cbranch_scc0 L_k2_fin
    s_sub_u32 s81, s85, s89
    s_cmp_gt_u32 s81, 2
    s_cbranch_scc1 L_k2_w2_A2
    s_cmp_gt_u32 s81, 1
    s_cbranch_scc1 L_k2_w1_A2
    s_waitcnt vmcnt(0)
    s_branch L_k2_wd_A2
L_k2_w2_A2:
    s_waitcnt vmcnt(6)
    s_branch L_k2_wd_A2
L_k2_w1_A2:
    s_waitcnt vmcnt(3)
L_k2_wd_A2:
    v_and_b32 v104, v56, v106
    v_and_b32 v105, v57, v106
    v_lshlrev_b32 v120, 16, v32
    v_and_b32 v121, 0xffff0000, v32
    v_mfma_f32_16x16x16_bf16 v[68:71], v[104:105], v[98:99], 0
    v_mfma_f32_16x16x16_bf16 v[72:75], v[104:105], v[100:101], 0
    v_mfma_f32_16x16x16_bf16 v[64:67], v[104:105], v[96:97], 0
    v_lshlrev_b32 v122, 16, v33
    v_and_b32 v123, 0xffff0000, v33
    v_lshlrev_b32 v124, 16, v34
    v_and_b32 v125, 0xffff0000, v34
    v_lshlrev_b32 v126, 16, v35
    v_and_b32 v127, 0xffff0000, v35
    v_lshlrev_b32 v112, 16, v36
    v_and_b32 v113, 0xffff0000, v36
    v_lshlrev_b32 v114, 16, v37
    v_and_b32 v115, 0xffff0000, v37
    v_lshlrev_b32 v116, 16, v38
    v_and_b32 v117, 0xffff0000, v38
    v_lshlrev_b32 v118, 16, v39
    v_and_b32 v119, 0xffff0000, v39
    v_mul_f32 v68, v120, v68
    v_mul_f32 v69, v121, v69
    v_mul_f32 v70, v122, v70
    v_mul_f32 v71, v123, v71
    v_mul_f32 v72, v124, v72
    v_mul_f32 v73, v125, v73
    v_mul_f32 v74, v126, v74
    v_mul_f32 v75, v127, v75
    v_fmac_f32 v8, v112, v64
    v_fmac_f32 v9, v113, v65
    v_fmac_f32 v10, v114, v66
    v_fmac_f32 v11, v115, v67
    v_fmac_f32 v12, v116, v68
    v_fmac_f32 v12, v59, v72
    v_fmac_f32 v13, v117, v69
    v_fmac_f32 v13, v59, v73
    v_fmac_f32 v14, v118, v70
    v_fmac_f32 v14, v59, v74
    v_fmac_f32 v15, v119, v71
    v_fmac_f32 v15, v59, v75
    s_add_u32 s81, s89, 3
    s_cmp_lt_u32 s81, s85
    s_cbranch_scc0 L_k2_ni_A2
    s_lshl_b32 s87, s81, 5
    v_add_u32 v81, s87, v4
    v_cmp_lt_u32 vcc, s81, v5
    v_add_u32 v78, s87, v107
    v_cmp_lt_u32 s[90:91], s81, v108
    v_cndmask_b32 v81, v109, v81, vcc
    ds_read_b64 v[58:59], v81 offset:8
    ds_read_b64 v[60:61], v81 offset:16
    v_cndmask_b32 v78, v109, v78, s[90:91]
    ds_read_b64 v[56:57], v78
    s_waitcnt lgkmcnt(0)
    v_mul_u32_u24 v81, 384, v58
    v_add_u32 v81, v81, v3
    buffer_load_dwordx4 v[32:35], v81, s[40:43], 0 offen
    v_mad_u32_u24 v81, v58, s39, v83
    buffer_load_dwordx2 v[36:37], v81, s[92:95], 0 offen
    v_lshl_add_u32 v81, v58, 11, v84
    buffer_load_dwordx2 v[38:39], v81, s[44:47], 0 offen
L_k2_ni_A2:
    s_add_u32 s89, s89, 1
    s_cmp_lt_u32 s89, s85
    s_cbranch_scc1 L_k2_loopA
    s_branch L_k2_fin
L_k2_loopB:
    s_sub_u32 s81, s85, s89
    s_cmp_gt_u32 s81, 2
    s_cbranch_scc1 L_k2_w2_B0
    s_cmp_gt_u32 s81, 1
    s_cbranch_scc1 L_k2_w1_B0
    s_waitcnt vmcnt(0)
    s_branch L_k2_wd_B0
L_k2_w2_B0:
    s_waitcnt vmcnt(6)
    s_branch L_k2_wd_B0
L_k2_w1_B0:
    s_waitcnt vmcnt(3)
L_k2_wd_B0:
    v_and_b32 v104, v40, v106
    v_and_b32 v105, v41, v106
    v_lshlrev_b32 v120, 16, v16
    v_and_b32 v121, 0xffff0000, v16
    v_mfma_f32_16x16x16_bf16 v[68:71], v[104:105], v[98:99], 0
    v_mfma_f32_16x16x16_bf16 v[72:75], v[104:105], v[100:101], 0
    v_lshlrev_b32 v122, 16, v17
    v_and_b32 v123, 0xffff0000, v17
    v_lshlrev_b32 v124, 16, v18
    v_and_b32 v125, 0xffff0000, v18
    v_lshlrev_b32 v126, 16, v19
    v_and_b32 v127, 0xffff0000, v19
    v_lshlrev_b32 v112, 16, v20
    v_and_b32 v113, 0xffff0000, v20
    v_lshlrev_b32 v114, 16, v21
    v_and_b32 v115, 0xffff0000, v21
    v_lshlrev_b32 v116, 16, v22
    v_and_b32 v117, 0xffff0000, v22
    v_lshlrev_b32 v118, 16, v23
    v_and_b32 v119, 0xffff0000, v23
    v_mul_f32 v68, v120, v68
    v_mul_f32 v69, v121, v69
    v_mul_f32 v70, v122, v70
    v_mul_f32 v71, v123, v71
    v_mul_f32 v72, v124, v72
    v_mul_f32 v73, v125, v73
    v_mul_f32 v74, v126, v74
    v_mul_f32 v75, v127, v75
    v_fmac_f32 v8, v112, v68
    v_fmac_f32 v8, v44, v72
    v_fmac_f32 v9, v113, v69
    v_fmac_f32 v9, v44, v73
    v_fmac_f32 v10, v114, v70
    v_fmac_f32 v10, v44, v74
    v_fmac_f32 v11, v115, v71
    v_fmac_f32 v11, v44, v75
    v_fmac_f32 v12, v116, v68
    v_fmac_f32 v12, v45, v72
    v_fmac_f32 v13, v117, v69
    v_fmac_f32 v13, v45, v73
    v_fmac_f32 v14, v118, v70
    v_fmac_f32 v14, v45, v74
    v_fmac_f32 v15, v119, v71
    v_fmac_f32 v15, v45, v75
    s_add_u32 s81, s89, 3
    s_cmp_lt_u32 s81, s85
    s_cbranch_scc0 L_k2_ni_B0
    s_lshl_b32 s87, s81, 5
    v_add_u32 v81, s87, v4
    v_cmp_lt_u32 vcc, s81, v5
    v_add_u32 v78, s87, v107
    v_cmp_lt_u32 s[90:91], s81, v108
    v_cndmask_b32 v81, v109, v81, vcc
    ds_read_b64 v[42:43], v81 offset:8
    ds_read_b64 v[44:45], v81 offset:16
    v_cndmask_b32 v78, v109, v78, s[90:91]
    ds_read_b64 v[40:41], v78
    s_waitcnt lgkmcnt(0)
    v_mul_u32_u24 v81, 384, v42
    v_add_u32 v81, v81, v3
    buffer_load_dwordx4 v[16:19], v81, s[40:43], 0 offen
    v_mad_u32_u24 v81, v42, s39, v83
    buffer_load_dwordx2 v[20:21], v81, s[92:95], 0 offen
    v_lshl_add_u32 v81, v42, 11, v84
    buffer_load_dwordx2 v[22:23], v81, s[44:47], 0 offen
L_k2_ni_B0:
    s_add_u32 s89, s89, 1
    s_cmp_lt_u32 s89, s85
    s_cbranch_scc0 L_k2_fin
    s_sub_u32 s81, s85, s89
    s_cmp_gt_u32 s81, 2
    s_cbranch_scc1 L_k2_w2_B1
    s_cmp_gt_u32 s81, 1
    s_cbranch_scc1 L_k2_w1_B1
    s_waitcnt vmcnt(0)
    s_branch L_k2_wd_B1
L_k2_w2_B1:
    s_waitcnt vmcnt(6)
    s_branch L_k2_wd_B1
L_k2_w1_B1:
    s_waitcnt vmcnt(3)
L_k2_wd_B1:
    v_and_b32 v104, v48, v106
    v_and_b32 v105, v49, v106
    v_lshlrev_b32 v120, 16, v24
    v_and_b32 v121, 0xffff0000, v24
    v_mfma_f32_16x16x16_bf16 v[68:71], v[104:105], v[98:99], 0
    v_mfma_f32_16x16x16_bf16 v[72:75], v[104:105], v[100:101], 0
    v_lshlrev_b32 v122, 16, v25
    v_and_b32 v123, 0xffff0000, v25
    v_lshlrev_b32 v124, 16, v26
    v_and_b32 v125, 0xffff0000, v26
    v_lshlrev_b32 v126, 16, v27
    v_and_b32 v127, 0xffff0000, v27
    v_lshlrev_b32 v112, 16, v28
    v_and_b32 v113, 0xffff0000, v28
    v_lshlrev_b32 v114, 16, v29
    v_and_b32 v115, 0xffff0000, v29
    v_lshlrev_b32 v116, 16, v30
    v_and_b32 v117, 0xffff0000, v30
    v_lshlrev_b32 v118, 16, v31
    v_and_b32 v119, 0xffff0000, v31
    v_mul_f32 v68, v120, v68
    v_mul_f32 v69, v121, v69
    v_mul_f32 v70, v122, v70
    v_mul_f32 v71, v123, v71
    v_mul_f32 v72, v124, v72
    v_mul_f32 v73, v125, v73
    v_mul_f32 v74, v126, v74
    v_mul_f32 v75, v127, v75
    v_fmac_f32 v8, v112, v68
    v_fmac_f32 v8, v52, v72
    v_fmac_f32 v9, v113, v69
    v_fmac_f32 v9, v52, v73
    v_fmac_f32 v10, v114, v70
    v_fmac_f32 v10, v52, v74
    v_fmac_f32 v11, v115, v71
    v_fmac_f32 v11, v52, v75
    v_fmac_f32 v12, v116, v68
    v_fmac_f32 v12, v53, v72
    v_fmac_f32 v13, v117, v69
    v_fmac_f32 v13, v53, v73
    v_fmac_f32 v14, v118, v70
    v_fmac_f32 v14, v53, v74
    v_fmac_f32 v15, v119, v71
    v_fmac_f32 v15, v53, v75
    s_add_u32 s81, s89, 3
    s_cmp_lt_u32 s81, s85
    s_cbranch_scc0 L_k2_ni_B1
    s_lshl_b32 s87, s81, 5
    v_add_u32 v81, s87, v4
    v_cmp_lt_u32 vcc, s81, v5
    v_add_u32 v78, s87, v107
    v_cmp_lt_u32 s[90:91], s81, v108
    v_cndmask_b32 v81, v109, v81, vcc
    ds_read_b64 v[50:51], v81 offset:8
    ds_read_b64 v[52:53], v81 offset:16
    v_cndmask_b32 v78, v109, v78, s[90:91]
    ds_read_b64 v[48:49], v78
    s_waitcnt lgkmcnt(0)
    v_mul_u32_u24 v81, 384, v50
    v_add_u32 v81, v81, v3
    buffer_load_dwordx4 v[24:27], v81, s[40:43], 0 offen
    v_mad_u32_u24 v81, v50, s39, v83
    buffer_load_dwordx2 v[28:29], v81, s[92:95], 0 offen
    v_lshl_add_u32 v81, v50, 11, v84
    buffer_load_dwordx2 v[30:31], v81, s[44:47], 0 offen
L_k2_ni_B1:
    s_add_u32 s89, s89, 1
    s_cmp_lt_u32 s89, s85
    s_cbranch_scc0 L_k2_fin
    s_sub_u32 s81, s85, s89
    s_cmp_gt_u32 s81, 2
    s_cbranch_scc1 L_k2_w2_B2
    s_cmp_gt_u32 s81, 1
    s_cbranch_scc1 L_k2_w1_B2
    s_waitcnt vmcnt(0)
    s_branch L_k2_wd_B2
L_k2_w2_B2:
    s_waitcnt vmcnt(6)
    s_branch L_k2_wd_B2
L_k2_w1_B2:
    s_waitcnt vmcnt(3)
L_k2_wd_B2:
    v_and_b32 v104, v56, v106
    v_and_b32 v105, v57, v106
    v_lshlrev_b32 v120, 16, v32
    v_and_b32 v121, 0xffff0000, v32
    v_mfma_f32_16x16x16_bf16 v[68:71], v[104:105], v[98:99], 0
    v_mfma_f32_16x16x16_bf16 v[72:75], v[104:105], v[100:101], 0
    v_lshlrev_b32 v122, 16, v33
    v_and_b32 v123, 0xffff0000, v33
    v_lshlrev_b32 v124, 16, v34
    v_and_b32 v125, 0xffff0000, v34
    v_lshlrev_b32 v126, 16, v35
    v_and_b32 v127, 0xffff0000, v35
    v_lshlrev_b32 v112, 16, v36
    v_and_b32 v113, 0xffff0000, v36
    v_lshlrev_b32 v114, 16, v37
    v_and_b32 v115, 0xffff0000, v37
    v_lshlrev_b32 v116, 16, v38
    v_and_b32 v117, 0xffff0000, v38
    v_lshlrev_b32 v118, 16, v39
    v_and_b32 v119, 0xffff0000, v39
    v_mul_f32 v68, v120, v68
    v_mul_f32 v69, v121, v69
    v_mul_f32 v70, v122, v70
    v_mul_f32 v71, v123, v71
    v_mul_f32 v72, v124, v72
    v_mul_f32 v73, v125, v73
    v_mul_f32 v74, v126, v74
    v_mul_f32 v75, v127, v75
    v_fmac_f32 v8, v112, v68
    v_fmac_f32 v8, v60, v72
    v_fmac_f32 v9, v113, v69
    v_fmac_f32 v9, v60, v73
    v_fmac_f32 v10, v114, v70
    v_fmac_f32 v10, v60, v74
    v_fmac_f32 v11, v115, v71
    v_fmac_f32 v11, v60, v75
    v_fmac_f32 v12, v116, v68
    v_fmac_f32 v12, v61, v72
    v_fmac_f32 v13, v117, v69
    v_fmac_f32 v13, v61, v73
    v_fmac_f32 v14, v118, v70
    v_fmac_f32 v14, v61, v74
    v_fmac_f32 v15, v119, v71
    v_fmac_f32 v15, v61, v75
    s_add_u32 s81, s89, 3
    s_cmp_lt_u32 s81, s85
    s_cbranch_scc0 L_k2_ni_B2
    s_lshl_b32 s87, s81, 5
    v_add_u32 v81, s87, v4
    v_cmp_lt_u32 vcc, s81, v5
    v_add_u32 v78, s87, v107
    v_cmp_lt_u32 s[90:91], s81, v108
    v_cndmask_b32 v81, v109, v81, vcc
    ds_read_b64 v[58:59], v81 offset:8
    ds_read_b64 v[60:61], v81 offset:16
    v_cndmask_b32 v78, v109, v78, s[90:91]
    ds_read_b64 v[56:57], v78
    s_waitcnt lgkmcnt(0)
    v_mul_u32_u24 v81, 384, v58
    v_add_u32 v81, v81, v3
    buffer_load_dwordx4 v[32:35], v81, s[40:43], 0 offen
    v_mad_u32_u24 v81, v58, s39, v83
    buffer_load_dwordx2 v[36:37], v81, s[92:95], 0 offen
    v_lshl_add_u32 v81, v58, 11, v84
    buffer_load_dwordx2 v[38:39], v81, s[44:47], 0 offen
L_k2_ni_B2:
    s_add_u32 s89, s89, 1
    s_cmp_lt_u32 s89, s85
    s_cbranch_scc1 L_k2_loopB
    s_branch L_k2_fin
L_k2_fin:
    s_cmp_eq_u32 s75, 1
    s_cbranch_scc1 L_k2_own1_ok
    v_mov_b32 v78, 3924
L_k2_own1_sp:
    ds_read_b32 v1, v78
    s_waitcnt lgkmcnt(0)
    v_readfirstlane_b32 s75, v1
    s_cmp_ge_u32 s75, 8
    s_cbranch_scc0 L_k2_own1_sp
    s_mov_b32 s75, 1
L_k2_own1_ok:
    ds_read_b64 v[86:87], v7
    ds_read_b64 v[88:89], v7 offset:128
    s_waitcnt lgkmcnt(0)
    v_lshlrev_b32 v120, 16, v86
    v_and_b32 v121, 0xffff0000, v86
    v_add_f32 v8, v8, v120
    v_add_f32 v9, v9, v121
    v_lshlrev_b32 v122, 16, v87
    v_and_b32 v123, 0xffff0000, v87
    v_add_f32 v10, v10, v122
    v_add_f32 v11, v11, v123
    v_lshlrev_b32 v124, 16, v88
    v_and_b32 v125, 0xffff0000, v88
    v_add_f32 v12, v12, v124
    v_add_f32 v13, v13, v125
    v_lshlrev_b32 v126, 16, v89
    v_and_b32 v127, 0xffff0000, v89
    v_add_f32 v14, v14, v126
    v_add_f32 v15, v15, v127
    v_cvt_pk_bf16_f32 v64, v8, v9
    v_cvt_pk_bf16_f32 v65, v10, v11
    v_cvt_pk_bf16_f32 v66, v12, v13
    v_cvt_pk_bf16_f32 v67, v14, v15
    buffer_store_dwordx2 v[64:65], v6, s[48:51], 0 offen offset:0 sc1
    buffer_store_dwordx2 v[66:67], v6, s[48:51], 0 offen offset:512 sc1
    s_branch L_k2_next
L_k2_slow:
    v_mul_u32_u24 v7, 24, v2
    ds_read_b64 v[96:97], v7 offset:4096
    ds_read_b64 v[98:99], v7 offset:4104
    ds_read_b64 v[100:101], v7 offset:4112
    v_lshrrev_b32 v106, 4, v2
    v_and_b32 v109, 3, v2
    v_cmp_eq_u32 vcc, v106, v109
    s_nop 1
    v_cndmask_b32 v106, 0, -1, vcc
    v_mov_b32 v109, 38400
    v_and_b32 v3, 15, v2
    v_lshlrev_b32 v82, 3, v3
    v_lshlrev_b32 v3, 4, v3
    s_cmp_eq_u32 s38, 0
    s_cselect_b32 s92, s40, s44
    s_cselect_b32 s93, s41, s45
    s_cselect_b32 s94, s42, s46
    s_cselect_b32 s95, s43, s47
    s_movk_i32 s39, 2048
    s_cselect_b32 s39, 384, s39
    s_lshl_b32 s77, s65, 7
    s_add_u32 s78, s77, 1024
    s_cmp_eq_u32 s38, 0
    s_cselect_b32 s78, 256, s78
    s_lshl_b32 s79, s38, 10
    s_add_u32 s79, s79, s77
    s_add_u32 s79, s79, 512
    v_add_u32 v83, s78, v82
    v_add_u32 v84, s79, v82
    s_mov_b32 s75, 0
    s_mov_b32 s80, s64
L_k2_snext:
    s_cmp_ge_u32 s80, s68
    s_cbranch_scc1 L_k2_exit
    s_add_u32 s81, s67, s80
    s_lshl_b32 s81, s81, 11
    s_lshl_b32 s84, s38, 10
    s_add_u32 s84, s84, s77
    s_add_u32 s81, s81, s84
    v_add_u32 v6, s81, v82
    s_lshl_b32 s81, s80, 8
    s_add_u32 s81, s81, 38912
    v_add_u32 v7, s81, v82
    v_mov_b32 v8, 0
    v_mov_b32 v9, 0
    v_mov_b32 v10, 0
    v_mov_b32 v11, 0
    v_mov_b32 v12, 0
    v_mov_b32 v13, 0
    v_mov_b32 v14, 0
    v_mov_b32 v15, 0
    s_mov_b32 s85, 0
    s_mul_i32 s90, s66, 3200000
    s_add_u32 s90, s90, 655360
    s_lshl_b32 s91, s66, 10
L_k2_sscan:
    s_cmp_ge_u32 s85, s72
    s_cbranch_scc1 L_k2_sfin
    v_add_u32 v78, s85, v2
    v_add_u32 v79, s91, v78
    v_mul_u32_u24 v79, 20, v79
    v_mul_u32_u24 v80, 20, v78
    v_add_u32 v80, s90, v80
    v_cmp_gt_u32 vcc, 1024, v78
    s_nop 1
    v_cndmask_b32 v80, v80, v79, vcc
    buffer_load_dword v79, v80, s[52:55], 0 offen
    s_waitcnt vmcnt(0)
    v_lshrrev_b32 v79, 14, v79
    v_cmp_eq_u32 vcc, s80, v79
    v_cmp_gt_u32 s[86:87], s72, v78
    s_and_b64 s[86:87], s[86:87], vcc
L_k2_smatch:
    s_cmp_eq_u64 s[86:87], 0
    s_cbranch_scc1 L_k2_sadv
    s_ff1_i32_b64 s88, s[86:87]
    s_bitset0_b64 s[86:87], s88
    v_readlane_b32 s89, v80, s88
    s_nop 3
    v_mov_b32 v78, s89
    buffer_load_dwordx4 v[112:115], v78, s[52:55], 0 offen
    buffer_load_dword v45, v78, s[52:55], 0 offen offset:16
    s_waitcnt vmcnt(0)
    v_and_b32 v42, 0x3fff, v112
    v_mov_b32 v40, v113
    v_mov_b32 v41, v114
    v_and_b32 v44, 0xffff0000, v115
    v_lshlrev_b32 v43, 16, v115
    v_lshlrev_b32 v45, 16, v45
    v_mul_u32_u24 v81, 384, v42
    v_add_u32 v81, v81, v3
    buffer_load_dwordx4 v[16:19], v81, s[40:43], 0 offen
    v_mad_u32_u24 v81, v42, s39, v83
    buffer_load_dwordx2 v[20:21], v81, s[92:95], 0 offen
    v_lshl_add_u32 v81, v42, 11, v84
    buffer_load_dwordx2 v[22:23], v81, s[44:47], 0 offen
    s_waitcnt vmcnt(0)
    s_cmp_eq_u32 s38, 0
    s_cbranch_scc0 L_k2_sB
    v_and_b32 v104, v40, v106
    v_and_b32 v105, v41, v106
    v_lshlrev_b32 v120, 16, v16
    v_and_b32 v121, 0xffff0000, v16
    v_mfma_f32_16x16x16_bf16 v[68:71], v[104:105], v[98:99], 0
    v_mfma_f32_16x16x16_bf16 v[72:75], v[104:105], v[100:101], 0
    v_mfma_f32_16x16x16_bf16 v[64:67], v[104:105], v[96:97], 0
    v_lshlrev_b32 v122, 16, v17
    v_and_b32 v123, 0xffff0000, v17
    v_lshlrev_b32 v124, 16, v18
    v_and_b32 v125, 0xffff0000, v18
    v_lshlrev_b32 v126, 16, v19
    v_and_b32 v127, 0xffff0000, v19
    v_lshlrev_b32 v112, 16, v20
    v_and_b32 v113, 0xffff0000, v20
    v_lshlrev_b32 v114, 16, v21
    v_and_b32 v115, 0xffff0000, v21
    v_lshlrev_b32 v116, 16, v22
    v_and_b32 v117, 0xffff0000, v22
    v_lshlrev_b32 v118, 16, v23
    v_and_b32 v119, 0xffff0000, v23
    v_mul_f32 v68, v120, v68
    v_mul_f32 v69, v121, v69
    v_mul_f32 v70, v122, v70
    v_mul_f32 v71, v123, v71
    v_mul_f32 v72, v124, v72
    v_mul_f32 v73, v125, v73
    v_mul_f32 v74, v126, v74
    v_mul_f32 v75, v127, v75
    v_fmac_f32 v8, v112, v64
    v_fmac_f32 v9, v113, v65
    v_fmac_f32 v10, v114, v66
    v_fmac_f32 v11, v115, v67
    v_fmac_f32 v12, v116, v68
    v_fmac_f32 v12, v43, v72
    v_fmac_f32 v13, v117, v69
    v_fmac_f32 v13, v43, v73
    v_fmac_f32 v14, v118, v70
    v_fmac_f32 v14, v43, v74
    v_fmac_f32 v15, v119, v71
    v_fmac_f32 v15, v43, v75
    s_branch L_k2_smatch
L_k2_sB:
    v_and_b32 v104, v40, v106
    v_and_b32 v105, v41, v106
    v_lshlrev_b32 v120, 16, v16
    v_and_b32 v121, 0xffff0000, v16
    v_mfma_f32_16x16x16_bf16 v[68:71], v[104:105], v[98:99], 0
    v_mfma_f32_16x16x16_bf16 v[72:75], v[104:105], v[100:101], 0
    v_lshlrev_b32 v122, 16, v17
    v_and_b32 v123, 0xffff0000, v17
    v_lshlrev_b32 v124, 16, v18
    v_and_b32 v125, 0xffff0000, v18
    v_lshlrev_b32 v126, 16, v19
    v_and_b32 v127, 0xffff0000, v19
    v_lshlrev_b32 v112, 16, v20
    v_and_b32 v113, 0xffff0000, v20
    v_lshlrev_b32 v114, 16, v21
    v_and_b32 v115, 0xffff0000, v21
    v_lshlrev_b32 v116, 16, v22
    v_and_b32 v117, 0xffff0000, v22
    v_lshlrev_b32 v118, 16, v23
    v_and_b32 v119, 0xffff0000, v23
    v_mul_f32 v68, v120, v68
    v_mul_f32 v69, v121, v69
    v_mul_f32 v70, v122, v70
    v_mul_f32 v71, v123, v71
    v_mul_f32 v72, v124, v72
    v_mul_f32 v73, v125, v73
    v_mul_f32 v74, v126, v74
    v_mul_f32 v75, v127, v75
    v_fmac_f32 v8, v112, v68
    v_fmac_f32 v8, v44, v72
    v_fmac_f32 v9, v113, v69
    v_fmac_f32 v9, v44, v73
    v_fmac_f32 v10, v114, v70
    v_fmac_f32 v10, v44, v74
    v_fmac_f32 v11, v115, v71
    v_fmac_f32 v11, v44, v75
    v_fmac_f32 v12, v116, v68
    v_fmac_f32 v12, v45, v72
    v_fmac_f32 v13, v117, v69
    v_fmac_f32 v13, v45, v73
    v_fmac_f32 v14, v118, v70
    v_fmac_f32 v14, v45, v74
    v_fmac_f32 v15, v119, v71
    v_fmac_f32 v15, v45, v75
    s_branch L_k2_smatch
L_k2_sadv:
    s_add_u32 s85, s85, 64
    s_branch L_k2_sscan
L_k2_sfin:
    s_cmp_eq_u32 s75, 1
    s_cbranch_scc1 L_k2_own2_ok
    v_mov_b32 v78, 3924
L_k2_own2_sp:
    ds_read_b32 v1, v78
    s_waitcnt lgkmcnt(0)
    v_readfirstlane_b32 s75, v1
    s_cmp_ge_u32 s75, 8
    s_cbranch_scc0 L_k2_own2_sp
    s_mov_b32 s75, 1
L_k2_own2_ok:
    ds_read_b64 v[86:87], v7
    ds_read_b64 v[88:89], v7 offset:128
    s_waitcnt lgkmcnt(0)
    s_mov_b64 exec, 0xffff
    v_lshlrev_b32 v120, 16, v86
    v_and_b32 v121, 0xffff0000, v86
    v_add_f32 v8, v8, v120
    v_add_f32 v9, v9, v121
    v_lshlrev_b32 v122, 16, v87
    v_and_b32 v123, 0xffff0000, v87
    v_add_f32 v10, v10, v122
    v_add_f32 v11, v11, v123
    v_lshlrev_b32 v124, 16, v88
    v_and_b32 v125, 0xffff0000, v88
    v_add_f32 v12, v12, v124
    v_add_f32 v13, v13, v125
    v_lshlrev_b32 v126, 16, v89
    v_and_b32 v127, 0xffff0000, v89
    v_add_f32 v14, v14, v126
    v_add_f32 v15, v15, v127
    v_cvt_pk_bf16_f32 v64, v8, v9
    v_cvt_pk_bf16_f32 v65, v10, v11
    v_cvt_pk_bf16_f32 v66, v12, v13
    v_cvt_pk_bf16_f32 v67, v14, v15
    buffer_store_dwordx2 v[64:65], v6, s[48:51], 0 offen offset:0 sc1
    buffer_store_dwordx2 v[66:67], v6, s[48:51], 0 offen offset:512 sc1
    s_mov_b64 exec, -1
    s_add_u32 s80, s80, 16
    s_branch L_k2_snext
L_k2_exit:
    s_endpgm
L_code_end:
.section .rodata,"a"
.p2align 6
.amdhsa_kernel painn_k1_kernel
  .amdhsa_next_free_vgpr 168
  .amdhsa_next_free_sgpr 102
  .amdhsa_accum_offset 168
  .amdhsa_group_segment_fixed_size 0
  .amdhsa_kernarg_size 88
  .amdhsa_user_sgpr_count 2
  .amdhsa_user_sgpr_kernarg_segment_ptr 1
  .amdhsa_system_sgpr_workgroup_id_x 1
  .amdhsa_float_denorm_mode_32 3
  .amdhsa_float_denorm_mode_16_64 3
.end_amdhsa_kernel

.p2align 6
.amdhsa_kernel painn_k2_kernel
  .amdhsa_next_free_vgpr 128
  .amdhsa_next_free_sgpr 102
  .amdhsa_accum_offset 128
  .amdhsa_group_segment_fixed_size 0
  .amdhsa_kernarg_size 88
  .amdhsa_user_sgpr_count 2
  .amdhsa_user_sgpr_kernarg_segment_ptr 1
  .amdhsa_system_sgpr_workgroup_id_x 1
  .amdhsa_float_denorm_mode_32 3
  .amdhsa_float_denorm_mode_16_64 3
.end_amdhsa_kernel
```
